```python
import torch

def _softmax(x, axis=-1):
    return torch.softmax(x, dim=axis)
def _gelu(x):
    return torch.nn.functional.gelu(x, approximate="tanh")
def _silu(x):
    return torch.nn.functional.silu(x)
def _sigmoid(x):
    return torch.sigmoid(x)
def _layernorm(x, axis=-1, eps=1e-5):
    m = x.mean(dim=axis, keepdim=True)
    v = x.var(dim=axis, keepdim=True, unbiased=False)
    return (x - m) / torch.sqrt(v + eps)
def _scatter_add(tgt, idx, src, axis=0):
    return tgt.clone().index_add_(axis, idx, src)
def _segment_sum(src, seg, n):
    out = torch.zeros((n,) + src.shape[1:], dtype=src.dtype)
    return out.index_add_(0, seg, src)
def _pad(x, pw):
    flat = tuple(v for pair in reversed(pw) for v in pair)
    return torch.nn.functional.pad(x, flat)

kernel_name = 'parallel_sum__ssm_conv_h3__moe_arch_mod__prompt'

def setup_inputs():

    _w = (lambda a: (lambda t: t.to(torch.bfloat16) if t.is_floating_point() else t)(torch.as_tensor(a)))
    def _A_setup():
        B, S, D = 1, 2048, 640
        ks = 4
        return {
            "q": _w((lambda *s: torch.randn(*s, dtype=torch.bfloat16) * 0.05)(B, S, D)),
            "k": _w((lambda *s: torch.randn(*s, dtype=torch.bfloat16) * 0.4)(B, S, D)),
            "v": _w((lambda *s: torch.randn(*s, dtype=torch.bfloat16) * 0.4)(B, S, D)),
            "shift_k": _w((lambda *s: torch.randn(*s, dtype=torch.bfloat16) * 0.4)(D, ks) * 0.5),
            "ssm_k": _w((lambda *s: torch.randn(*s, dtype=torch.bfloat16) * 1.6)(D, S) * (1.0 / S ** 0.5)),
            "ssm_D": _w((lambda *s: torch.randn(*s, dtype=torch.bfloat16) * 0.4)(D)),
        }
    _A_in = _A_setup()

    def _B_setup():
        B, S, D, F, C = 1, 2048, 640, 1728, 2
        return {
            "x": _w((lambda *s: torch.randn(*s, dtype=torch.bfloat16) * 0.05)(B, S, D)),
            "w_r": _w((lambda *s: torch.randn(*s, dtype=torch.bfloat16) * 0.05)(D)),
            "w_gate": _w((lambda *s: torch.randn(*s, dtype=torch.bfloat16) * 0.05)(D, F)),
            "w_up": _w((lambda *s: torch.randn(*s, dtype=torch.bfloat16) * 0.05)(D, F)),
            "w_down": _w((lambda *s: torch.randn(*s, dtype=torch.bfloat16) * 0.05)(F, D)),
        }
    _B_in = _B_setup()

    return {
        "A_q": _A_in["q"],
        "A_k": _A_in["k"],
        "A_v": _A_in["v"],
        "A_shift_k": _A_in["shift_k"],
        "A_ssm_k": _A_in["ssm_k"],
        "A_ssm_D": _A_in["ssm_D"],
        "B_x": _B_in["x"],
        "B_w_r": _B_in["w_r"],
        "B_w_gate": _B_in["w_gate"],
        "B_w_up": _B_in["w_up"],
        "B_w_down": _B_in["w_down"],
    }

def reference(A_q, A_k, A_v, A_shift_k, A_ssm_k, A_ssm_D, B_x, B_w_r, B_w_gate, B_w_up, B_w_down):
    def _A_ref(q, k, v, shift_k, ssm_k, ssm_D):
        B, S, D = q.shape
        ks = shift_k.shape[-1]
        k_pad = _pad(k, ((0, 0), (ks - 1, 0), (0, 0)))
        k_shift = torch.zeros_like(k)
        for t in range(ks):
            k_shift = k_shift + k_pad[:, t:t + S, :] * shift_k[:, ks - 1 - t][None, None, :]
        kv = k_shift * v
        L = 2 * S
        kv_pad = _pad(kv, ((0, 0), (0, S), (0, 0)))
        kf_pad = _pad(ssm_k, ((0, 0), (0, S)))
        kv_f = (lambda x, axes=(-2,-1): torch.fft.rfft2(x.float(), dim=axes))(kv_pad[:, None, :, :], axes=(1, 2))
        kf_f = (lambda x, axes=(-2,-1): torch.fft.rfft2(x.float(), dim=axes))(kf_pad[:, None, :], axes=(1, 2))
        kf_f = (lambda x, *d: x.permute(*d))(kf_f, 1, 2, 0)
        y_f = kv_f * kf_f[None, :, :, :]
        y = (lambda x, s, axes=(-2,-1): torch.fft.irfft2(x, s=s, dim=axes).to(torch.bfloat16))(y_f, (1, L), axes=(1, 2))[:, 0, :S, :]
        y = y + kv * ssm_D[None, None, :]
        return q * y

    def _B_ref(x, w_r, w_gate, w_up, w_down):
        B, S, D = x.shape
        C = 2
        r = x @ w_r
        idx = torch.argsort(-r, axis=-1)[:, :C]
        idx_e = (lambda x, n, axis: torch.repeat_interleave(x, n, dim=axis))(idx.reshape(B, C, 1), D, axis=2)
        x_sel = (lambda x, i, axis: torch.take_along_dim(x, i, dim=axis))(x, idx_e, axis=1)
        g = _silu(x_sel @ w_gate)
        u = x_sel @ w_up
        y = (g * u) @ w_down
        r_sel = _sigmoid((lambda x, i, axis: torch.take_along_dim(x, i, dim=axis))(r, idx, axis=1))
        y = y * r_sel.reshape(B, C, 1)
        b_off = (torch.arange(B) * S).reshape(B, 1)
        flat_idx = (idx + b_off).reshape(B * C)
        zero = (x * 0.0).reshape(B * S, D)
        upd = _scatter_add(zero, flat_idx, y.reshape(B * C, D), axis=0)
        return x + upd.reshape(B, S, D)

    x = A_q
    xn = _layernorm(x, axis=-1)
    return x + _A_ref(xn, A_k, A_v, A_shift_k, A_ssm_k, A_ssm_D) + _B_ref(xn, B_w_r, B_w_gate, B_w_up, B_w_down)
```

```asm
; @launch grid=(256,1,1) block=(512,1,1) lds=151552
.amdgcn_target "amdgcn-amd-amdhsa--gfx950"
.text
.globl parallel_sum__ssm_conv_h3__moe_arch_mod__prompt_kernel
.p2align 8
.type parallel_sum__ssm_conv_h3__moe_arch_mod__prompt_kernel,@function
parallel_sum__ssm_conv_h3__moe_arch_mod__prompt_kernel:
    s_cmp_ge_u32 s2, 256
    s_cbranch_scc1 L_end
    s_load_dwordx16 s[8:23], s[0:1], 0
    s_load_dwordx8 s[24:31], s[0:1], 64
    s_load_dwordx4 s[32:35], s[0:1], 96
    v_lshrrev_b32 v1, 6, v0
    v_mov_b32 v9, v0
    v_and_b32 v0, 63, v0
    s_and_b32 s3, s2, 7
    s_lshr_b32 s4, s2, 3
    v_readfirstlane_b32 s5, v1
    s_getreg_b32 s7, hwreg(HW_REG_XCC_ID)
    s_mov_b32 s52, 0xffff0000
    s_mul_i32 s53, s3, 20
    s_add_u32 s53, s53, s4
    s_sub_u32 s63, s4, 20
    s_cmp_ge_u32 s63, 8
    s_cbranch_scc1 L_nocw2
    s_getpc_b64 s[54:55]
L_pc2:
    s_sub_u32 s54, s54, L_pc2-parallel_sum__ssm_conv_h3__moe_arch_mod__prompt_kernel
    s_subb_u32 s55, s55, 0
    v_subrev_u32 v1, 320, v9
    v_lshlrev_b32 v1, 7, v1
    v_cmp_gt_u32 vcc, L_codeend-parallel_sum__ssm_conv_h3__moe_arch_mod__prompt_kernel, v1
    s_nop 0
    s_and_saveexec_b64 s[56:57], vcc
    s_cbranch_execz L_nocw3
    global_load_dword v127, v1, s[54:55]
L_nocw3:
    s_mov_b64 exec, -1
L_nocw2:
    s_sub_u32 s58, s4, 8
    s_cmp_lt_u32 s4, 20
    s_cselect_b32 s58, s4, s58
    s_cmp_lg_u32 s5, 0
    s_cbranch_scc1 L_not7
    s_mov_b32 s99, s2
L_ln:
    v_lshlrev_b32 v4, 4, v0
    s_mul_i32 s55, s99, 10240
    s_mov_b32 s42, 2621440
    s_mov_b32 s43, 0x20000
    s_movk_i32 s46, 1280
    s_mov_b32 s47, 0x20000
    s_mov_b32 m0, 140032
    s_waitcnt lgkmcnt(0)
    s_mov_b64 s[40:41], s[8:9]
    s_mov_b64 s[44:45], s[22:23]
    buffer_load_dwordx4 v4, s[40:43], s55 offen offset:0 lds
    buffer_load_dwordx4 v4, s[40:43], s55 offen offset:1024 lds
    buffer_load_dwordx4 v4, s[40:43], s55 offen offset:2048 lds
    buffer_load_dwordx4 v4, s[40:43], s55 offen offset:3072 lds
    s_mov_b32 m0, 144128
    s_add_u32 s55, s55, 4096
    buffer_load_dwordx4 v4, s[40:43], s55 offen offset:0 lds
    buffer_load_dwordx4 v4, s[40:43], s55 offen offset:1024 lds
    buffer_load_dwordx4 v4, s[40:43], s55 offen offset:2048 lds
    buffer_load_dwordx4 v4, s[40:43], s55 offen offset:3072 lds
    s_mov_b32 m0, 148224
    s_add_u32 s55, s55, 4096
    buffer_load_dwordx4 v4, s[40:43], s55 offen offset:0 lds
    buffer_load_dwordx4 v4, s[40:43], s55 offen offset:1024 lds
    s_mov_b32 m0, 150272
    s_nop 0
    buffer_load_dwordx4 v4, s[44:47], 0 offen lds
    s_mov_b64 exec, 0xffff
    buffer_load_dwordx4 v4, s[44:47], 0 offen offset:1024 lds
    s_mov_b64 exec, -1
    s_barrier
    s_branch L_lntail
L_not7:
    s_cmp_lt_u32 s63, 8
    s_cbranch_scc1 L_nonp1
    v_subrev_u32 v9, 64, v9
    s_mul_i32 s60, s58, 20
    s_sub_u32 s60, s60, 224
    s_mul_i32 s55, s58, 9
    s_movk_i32 s57, 3641
    s_cmp_lt_u32 s4, 20
    s_cselect_b32 s60, s55, s60
    s_cselect_b32 s61, 9, 10
    s_cselect_b32 s57, s57, 3277
    s_mul_i32 s59, s61, 81
    s_add_u32 s59, s59, 79
    s_mul_i32 s55, s60, 10240
    s_mul_i32 s54, s3, 160
    s_add_u32 s55, s55, s54
    s_sub_u32 s55, s55, 10240
    v_mov_b32 v7, 0x7ffffff0
    v_add_u32 v4, 50, v9
    v_mul_u32_u24 v5, 1619, v4
    v_lshrrev_b32 v5, 17, v5
    v_mul_u32_u24 v6, 81, v5
    v_cmp_gt_u32 vcc, 81, v4
    v_sub_u32 v4, v4, v6
    v_mul_u32_u24 v6, 205, v4
    v_lshrrev_b32 v6, 11, v6
    v_lshl_add_u32 v5, v5, 3, v6
    v_mul_u32_u24 v6, 10, v6
    v_sub_u32 v4, v4, v6
    v_mul_u32_u24 v5, 1280, v5
    v_lshl_add_u32 v5, v4, 4, v5
    v_add_u32 v1, s55, v5
    v_cndmask_b32 v3, v1, v7, vcc
    v_add_u32 v4, 498, v9
    v_mul_u32_u24 v5, 1619, v4
    v_lshrrev_b32 v5, 17, v5
    v_mul_u32_u24 v6, 81, v5
    v_cmp_lt_u32 vcc, s59, v4
    v_sub_u32 v4, v4, v6
    v_mul_u32_u24 v6, 205, v4
    v_lshrrev_b32 v6, 11, v6
    v_lshl_add_u32 v5, v5, 3, v6
    v_mul_u32_u24 v6, 10, v6
    v_sub_u32 v4, v4, v6
    v_mul_u32_u24 v5, 1280, v5
    v_lshl_add_u32 v5, v4, 4, v5
    v_add_u32 v2, s55, v5
    v_cndmask_b32 v2, v2, v7, vcc
    s_mul_i32 s96, s61, 40
    s_sub_u32 s59, s96, 1
    v_min_u32 v9, s59, v9
    v_mul_u32_u24 v7, s57, v9
    v_lshrrev_b32 v7, 15, v7
    v_mul_u32_u24 v8, s61, v7
    v_sub_u32 v8, v9, v8
    s_mul_i32 s54, s3, 640
    v_lshl_add_u32 v9, v7, 4, s54
    s_lshl_b32 s56, s5, 10
    s_add_u32 s56, s56, 102816
    s_lshl_b32 s97, s5, 6
    s_add_u32 s96, s96, 64
    s_waitcnt lgkmcnt(0)
    s_load_dword s6, s[34:35], 0
    s_mov_b32 s36, s34
    s_mov_b32 s37, s35
    s_mov_b32 s38, 0x1000000
    s_mov_b32 s39, 0x20000
    s_mov_b32 s40, s10
    s_mov_b32 s41, s11
    s_mov_b32 s42, 0x280000
    s_mov_b32 s43, 0x20000
    s_mov_b32 s44, s12
    s_mov_b32 s45, s13
    s_mov_b32 s46, 0x280000
    s_mov_b32 s47, 0x20000
    s_barrier
    s_add_u32 m0, s56, 0
    s_nop 0
    buffer_load_dwordx4 v1, s[40:43], 0 offen lds
    s_add_u32 m0, s56, 15136
    s_nop 0
    buffer_load_dwordx4 v3, s[44:47], 0 offen lds
    s_cmp_lt_u32 s4, 20
    s_cselect_b32 s55, s5, 0
    s_cmp_ge_u32 s55, 6
    s_cbranch_scc1 L_sk2
    s_add_u32 m0, s56, 7168
    s_nop 0
    buffer_load_dwordx4 v2, s[40:43], 0 offen lds
    s_add_u32 m0, s56, 22304
    s_nop 0
    buffer_load_dwordx4 v2, s[44:47], 0 offen lds
L_sk2:
    global_load_dwordx4 v[20:23], v9, s[14:15]
    s_cmp_lt_u32 s4, 20
    s_cbranch_scc1 L_nodma
    s_barrier
    s_mov_b32 s55, 102400
    s_add_u32 m0, s56, -30272
    s_nop 0
    buffer_load_dwordx4 v1, s[40:43], s55 offen lds
    s_add_u32 m0, s56, -15136
    s_nop 0
    buffer_load_dwordx4 v3, s[44:47], s55 offen lds
    s_add_u32 m0, s56, -23104
    s_nop 0
    buffer_load_dwordx4 v2, s[40:43], s55 offen lds
    s_add_u32 m0, s56, -7968
    s_nop 0
    buffer_load_dwordx4 v2, s[44:47], s55 offen lds
L_nodma:
    s_lshl_b32 s62, s53, 2
    s_and_b32 s54, s5, 3
    s_add_u32 s62, s62, s54
    s_min_u32 s62, s62, 639
    s_lshl_b32 s54, s62, 1
    s_and_b32 s54, s54, -4
    s_load_dword s63, s[18:19], s54
    v_mul_u32_u24 v1, 1296, v8
    v_lshl_add_u32 v1, v7, 2, v1
    v_add_u32 v1, 103040, v1
    s_mul_i32 s55, s3, 337920
    s_lshl_b32 s57, s60, 4
    s_add_u32 s55, s55, s57
    s_add_u32 s55, s55, 1048576
    v_mul_u32_u24 v5, 8448, v7
    v_lshl_add_u32 v5, v8, 4, v5
    v_add_u32 v5, s55, v5
    s_cmp_lg_u32 s5, 7
    s_cbranch_scc1 L_nz
    s_cmp_ge_u32 s4, 20
    s_cbranch_scc1 L_nz
    v_mov_b32 v16, 0
    v_mov_b32 v17, 0
    v_mov_b32 v18, 0
    v_mov_b32 v19, 0
    v_lshrrev_b32 v2, 5, v0
    v_mul_u32_u24 v2, 4576, v2
    v_and_b32 v3, 31, v0
    v_min_u32 v3, 27, v3
    v_lshl_add_u32 v2, v3, 4, v2
    v_add_u32 v2, 66560, v2
    ds_write_b128 v2, v[16:19] offset:0
    ds_write_b128 v2, v[16:19] offset:9120
    ds_write_b128 v2, v[16:19] offset:18240
    ds_write_b128 v2, v[16:19] offset:27360
    v_lshrrev_b32 v2, 2, v0
    v_mul_u32_u24 v2, 4160, v2
    v_and_b32 v3, 3, v0
    v_min_u32 v3, 2, v3
    v_lshl_add_u32 v2, v3, 4, v2
    ds_write_b128 v2, v[16:19]
L_nz:
    s_waitcnt lgkmcnt(0)
    s_mul_i32 s6, s6, 0x9E3779B1
    s_add_u32 s6, s6, 0x7F4A7C15
    s_cmp_lt_u32 s4, 20
    s_cselect_b32 s61, 0, 1
    s_cbranch_scc0 L_w8
    s_waitcnt vmcnt(0)
L_w8:
    s_waitcnt vmcnt(4)
    v_lshlrev_b32 v10, 16, v20
    v_lshlrev_b32 v11, 16, v22
    v_and_b32 v12, s52, v20
    v_and_b32 v13, s52, v22
    v_lshlrev_b32 v14, 16, v21
    v_lshlrev_b32 v15, 16, v23
    v_and_b32 v16, s52, v21
    v_and_b32 v17, s52, v23
L_round:
    s_barrier
    s_cmp_ge_u32 s97, s96
    s_cbranch_scc1 L_nokv
    ds_read_b32 v20, v1 offset:800
    ds_read_b32 v21, v1 offset:960
    ds_read_b32 v22, v1 offset:1120
    ds_read_b32 v23, v1 offset:1296
    ds_read_b32 v24, v1 offset:1456
    ds_read_b32 v25, v1 offset:1616
    ds_read_b32 v26, v1 offset:1776
    ds_read_b32 v27, v1 offset:1936
    ds_read_b32 v28, v1 offset:2096
    ds_read_b32 v29, v1 offset:2256
    ds_read_b32 v30, v1 offset:2416
    ds_read_b32 v32, v1 offset:16432
    ds_read_b32 v33, v1 offset:16592
    ds_read_b32 v34, v1 offset:16752
    ds_read_b32 v35, v1 offset:16912
    s_waitcnt lgkmcnt(11)
    v_lshlrev_b32 v40, 16, v20
    v_and_b32 v41, s52, v20
    v_lshlrev_b32 v42, 16, v21
    v_and_b32 v43, s52, v21
    v_lshlrev_b32 v44, 16, v22
    v_and_b32 v45, s52, v22
    v_lshlrev_b32 v46, 16, v23
    v_and_b32 v47, s52, v23
    s_waitcnt lgkmcnt(7)
    v_lshlrev_b32 v48, 16, v24
    v_and_b32 v49, s52, v24
    v_lshlrev_b32 v50, 16, v25
    v_and_b32 v51, s52, v25
    v_lshlrev_b32 v52, 16, v26
    v_and_b32 v53, s52, v26
    v_lshlrev_b32 v54, 16, v27
    v_and_b32 v55, s52, v27
    ds_read_b32 v36, v1 offset:17072
    ds_read_b32 v37, v1 offset:17232
    ds_read_b32 v38, v1 offset:17392
    ds_read_b32 v39, v1 offset:17552
    s_waitcnt lgkmcnt(8)
    v_lshlrev_b32 v56, 16, v28
    v_and_b32 v57, s52, v28
    v_lshlrev_b32 v58, 16, v29
    v_and_b32 v59, s52, v29
    v_lshlrev_b32 v60, 16, v30
    v_and_b32 v61, s52, v30
    v_pk_mul_f32 v[96:97], v[16:17], v[40:41]
    v_pk_mul_f32 v[98:99], v[16:17], v[42:43]
    v_pk_mul_f32 v[100:101], v[16:17], v[44:45]
    v_pk_mul_f32 v[102:103], v[16:17], v[46:47]
    v_pk_mul_f32 v[104:105], v[16:17], v[48:49]
    v_pk_mul_f32 v[106:107], v[16:17], v[50:51]
    v_pk_mul_f32 v[108:109], v[16:17], v[52:53]
    v_pk_mul_f32 v[110:111], v[16:17], v[54:55]
    v_pk_fma_f32 v[96:97], v[14:15], v[42:43], v[96:97]
    v_pk_fma_f32 v[98:99], v[14:15], v[44:45], v[98:99]
    v_pk_fma_f32 v[100:101], v[14:15], v[46:47], v[100:101]
    v_pk_fma_f32 v[102:103], v[14:15], v[48:49], v[102:103]
    v_pk_fma_f32 v[104:105], v[14:15], v[50:51], v[104:105]
    v_pk_fma_f32 v[106:107], v[14:15], v[52:53], v[106:107]
    v_pk_fma_f32 v[108:109], v[14:15], v[54:55], v[108:109]
    v_pk_fma_f32 v[110:111], v[14:15], v[56:57], v[110:111]
    v_pk_fma_f32 v[96:97], v[12:13], v[44:45], v[96:97]
    v_pk_fma_f32 v[98:99], v[12:13], v[46:47], v[98:99]
    v_pk_fma_f32 v[100:101], v[12:13], v[48:49], v[100:101]
    v_pk_fma_f32 v[102:103], v[12:13], v[50:51], v[102:103]
    v_pk_fma_f32 v[104:105], v[12:13], v[52:53], v[104:105]
    v_pk_fma_f32 v[106:107], v[12:13], v[54:55], v[106:107]
    v_pk_fma_f32 v[108:109], v[12:13], v[56:57], v[108:109]
    v_pk_fma_f32 v[110:111], v[12:13], v[58:59], v[110:111]
    v_pk_fma_f32 v[96:97], v[10:11], v[46:47], v[96:97]
    v_pk_fma_f32 v[98:99], v[10:11], v[48:49], v[98:99]
    v_pk_fma_f32 v[100:101], v[10:11], v[50:51], v[100:101]
    v_pk_fma_f32 v[102:103], v[10:11], v[52:53], v[102:103]
    v_pk_fma_f32 v[104:105], v[10:11], v[54:55], v[104:105]
    v_pk_fma_f32 v[106:107], v[10:11], v[56:57], v[106:107]
    v_pk_fma_f32 v[108:109], v[10:11], v[58:59], v[108:109]
    v_pk_fma_f32 v[110:111], v[10:11], v[60:61], v[110:111]
    s_waitcnt lgkmcnt(0)
    v_lshlrev_b32 v62, 16, v32
    v_and_b32 v63, s52, v32
    v_lshlrev_b32 v64, 16, v33
    v_and_b32 v65, s52, v33
    v_lshlrev_b32 v66, 16, v34
    v_and_b32 v67, s52, v34
    v_lshlrev_b32 v68, 16, v35
    v_and_b32 v69, s52, v35
    v_lshlrev_b32 v70, 16, v36
    v_and_b32 v71, s52, v36
    v_lshlrev_b32 v72, 16, v37
    v_and_b32 v73, s52, v37
    v_lshlrev_b32 v74, 16, v38
    v_and_b32 v75, s52, v38
    v_lshlrev_b32 v76, 16, v39
    v_and_b32 v77, s52, v39
    v_pk_mul_f32 v[96:97], v[96:97], v[62:63]
    v_pk_mul_f32 v[98:99], v[98:99], v[64:65]
    v_pk_mul_f32 v[100:101], v[100:101], v[66:67]
    v_pk_mul_f32 v[102:103], v[102:103], v[68:69]
    v_pk_mul_f32 v[104:105], v[104:105], v[70:71]
    v_pk_mul_f32 v[106:107], v[106:107], v[72:73]
    v_pk_mul_f32 v[108:109], v[108:109], v[74:75]
    v_pk_mul_f32 v[110:111], v[110:111], v[76:77]
    s_mov_b32 s55, 4224
    v_cvt_pk_bf16_f32 v80, v110, v108
    v_cvt_pk_bf16_f32 v81, v106, v104
    v_cvt_pk_bf16_f32 v82, v102, v100
    v_cvt_pk_bf16_f32 v83, v98, v96
    buffer_store_dwordx4 v[80:83], v5, s[36:39], 0 offen
    v_cvt_pk_bf16_f32 v84, v111, v109
    v_cvt_pk_bf16_f32 v85, v107, v105
    v_cvt_pk_bf16_f32 v86, v103, v101
    v_cvt_pk_bf16_f32 v87, v99, v97
    buffer_store_dwordx4 v[84:87], v5, s[36:39], s55 offen
L_nokv:
    s_sub_u32 s61, s61, 1
    s_cbranch_scc1 L_kvdone
    v_subrev_u32 v1, 30272, v1
    v_add_u32 v5, 160, v5
    s_waitcnt vmcnt(2)
    s_branch L_round
L_kvdone:
    s_lshl_b32 s55, s3, 11
    s_lshl_b32 s57, s58, 3
    s_add_u32 s57, s57, s55
    v_mov_b32 v10, s6
    v_mov_b32 v11, s7
    v_mov_b32 v12, s57
    v_min_u32 v1, 23, v0
    v_lshl_add_u32 v1, v1, 3, s55
    s_lshl_b32 s54, s53, 2
    s_add_u32 s54, s54, s5
    s_mul_i32 s54, s54, 4224
    s_add_u32 s54, s54, 1048576
    v_lshl_add_u32 v44, v0, 4, s54
    v_subrev_u32 v14, 16, v44
    v_cmp_eq_u32 vcc, 0, v0
    v_mov_b32 v3, 0x7ffffff0
    s_nop 0
    v_cndmask_b32 v14, v14, v3, vcc
    s_mov_b32 s55, 4096
    s_mov_b32 s59, 0
    s_mov_b32 s60, 1048576
    s_mov_b32 s61, 4096
    s_waitcnt vmcnt(0)
    s_barrier
    s_cmp_ge_u32 s5, 4
    s_cbranch_scc1 L_hi4
    s_cmp_lg_u32 s5, 0
    s_cbranch_scc1 L_poll
    s_cmp_lt_u32 s4, 20
    s_cselect_b32 s57, s55, 4128
    s_mov_b64 exec, 0x1
    buffer_store_dwordx2 v[10:11], v12, s[36:39], s57 offen
    s_mov_b64 exec, -1
L_poll:
    buffer_load_dwordx2 v[2:3], v1, s[36:39], s55 offen sc1
    s_add_u32 s59, s59, 1
    s_waitcnt vmcnt(0)
    v_cmp_eq_u64 vcc, s[6:7], v[2:3]
    s_nop 0
    s_cmp_eq_u64 vcc, -1
    s_cbranch_scc1 L_synced
    s_and_b32 s57, s59, 15
    s_cmp_lg_u32 s57, 0
    s_cbranch_scc1 L_poll
    s_branch L_slowsync
L_synced:
    s_cmp_ge_u32 s4, 20
    s_cbranch_scc1 L_special
    buffer_load_dwordx4 v[16:19], v44, s[36:39], 0 offen offset:0 sc1
    buffer_load_dword v28, v14, s[36:39], 0 offen sc1
    buffer_load_dwordx4 v[20:23], v44, s[36:39], 0 offen offset:1024 sc1
    buffer_load_dword v29, v44, s[36:39], 0 offen offset:1008 sc1
    s_mov_b32 exec_lo, 0xffffffff
    s_mov_b32 exec_hi, 0x0
    buffer_load_dwordx4 v[24:27], v44, s[36:39], 0 offen offset:2048 sc1
    buffer_load_dword v30, v44, s[36:39], 0 offen offset:2032 sc1
    s_mov_b64 exec, -1
    s_mul_i32 s55, s5, 9120
    s_add_u32 s55, s55, 67008
    v_lshl_add_u32 v45, v0, 4, s55
    v_mov_b32 v2, 139776
    v_mov_b32 v3, s61
    ds_write_b32 v2, v3
    v_min_u32 v4, 11, v0
    v_lshl_add_u32 v4, v4, 7, s54
    s_mul_i32 s54, s3, 160
    s_lshl_b32 s55, s5, 6
    s_lshl_b32 s56, s4, 8
    s_add_u32 s55, s55, s56
    v_add_u32 v8, s55, v0
    v_mul_u32_u24 v1, 6554, v8
    v_lshrrev_b32 v1, 18, v1
    v_mul_u32_u24 v10, 40, v1
    v_sub_u32 v8, v8, v10
    v_add_u32 v2, 128, v1
    v_lshlrev_b32 v3, 3, v8
    v_mul_u32_u24 v9, 10240, v1
    v_lshl_add_u32 v9, v8, 2, v9
    v_add_u32 v5, s54, v9
    v_add_u32 v6, 1310720, v5
    s_mov_b32 s40, s8
    s_mov_b32 s41, s9
    s_mov_b32 s42, 0x280000
    s_mov_b32 s43, 0x20000
    s_movk_i32 s49, 5120
    s_mov_b32 s57, 98304
    s_mov_b32 s58, 106496
    v_and_b32 v7, 7, v0
    v_lshl_add_u32 v7, v1, 3, v7
    v_lshlrev_b32 v7, 3, v7
    s_waitcnt vmcnt(4)
    ds_write_b128 v45, v[16:19] offset:4576
    v_alignbyte_b32 v32, v17, v16, 2
    v_alignbyte_b32 v33, v18, v17, 2
    v_alignbyte_b32 v34, v19, v18, 2
    v_alignbyte_b32 v35, v28, v19, 2
    ds_write_b128 v45, v[32:35] offset:0
    s_waitcnt vmcnt(2)
    ds_write_b128 v45, v[20:23] offset:5600
    v_alignbyte_b32 v36, v21, v20, 2
    v_alignbyte_b32 v37, v22, v21, 2
    v_alignbyte_b32 v38, v23, v22, 2
    v_alignbyte_b32 v39, v29, v23, 2
    ds_write_b128 v45, v[36:39] offset:1024
    s_waitcnt vmcnt(0)
    s_mov_b32 exec_lo, 0xffffffff
    s_mov_b32 exec_hi, 0x0
    ds_write_b128 v45, v[24:27] offset:6624
    v_alignbyte_b32 v40, v25, v24, 2
    v_alignbyte_b32 v41, v26, v25, 2
    v_alignbyte_b32 v42, v27, v26, 2
    v_alignbyte_b32 v43, v30, v27, 2
    ds_write_b128 v45, v[40:43] offset:2048
    s_mov_b64 exec, -1
    s_mov_b32 s51, s60
    s_mul_i32 s54, s3, 337920
    s_add_u32 s60, s60, s54
    s_add_u32 s48, s60, 4224
    s_lshl_b32 s54, s3, 11
    s_add_u32 s61, s61, s54
    s_add_u32 s61, s61, 512
    v_mul_u32_u24 v8, 1056, v3
    v_lshl_add_u32 v8, v1, 4, v8
    s_lshl_b32 s54, s3, 7
    s_add_u32 s54, s54, 40960
    v_mov_b32 v9, s54
    s_lshl_b32 s55, s5, 2
    s_add_u32 s55, s55, 139792
    v_mov_b32 v47, s55
    v_and_b32 v46, 3, v0
    v_lshlrev_b32 v46, 3, v46
    s_cmp_eq_u32 s51, 1048576
    s_cselect_b32 s96, 24, 20
    s_lshl_b32 s96, s96, 3
    s_sub_u32 s55, s61, 512
    s_add_u32 s96, s96, s55
    buffer_load_dwordx2 v[12:13], v7, s[36:39], s57 offen
    buffer_load_dwordx2 v[14:15], v7, s[36:39], s58 offen
    buffer_load_dword v48, v5, s[40:43], 0 offen offset:0
    buffer_load_dword v49, v5, s[40:43], 0 offen offset:1280
    buffer_load_dword v50, v5, s[40:43], 0 offen offset:2560
    buffer_load_dword v51, v5, s[40:43], 0 offen offset:3840
    buffer_load_dword v52, v5, s[40:43], s49 offen offset:0
    buffer_load_dword v53, v5, s[40:43], s49 offen offset:1280
    buffer_load_dword v54, v5, s[40:43], s49 offen offset:2560
    buffer_load_dword v55, v5, s[40:43], s49 offen offset:3840
    s_waitcnt lgkmcnt(0)
    s_barrier
L_final:
    buffer_load_dword v40, v46, s[36:39], s96 offen sc1
    buffer_load_dword v56, v6, s[40:43], 0 offen offset:0
    buffer_load_dword v57, v6, s[40:43], 0 offen offset:1280
    buffer_load_dword v58, v6, s[40:43], 0 offen offset:2560
    buffer_load_dword v59, v6, s[40:43], 0 offen offset:3840
    buffer_load_dword v60, v6, s[40:43], s49 offen offset:0
    buffer_load_dword v61, v6, s[40:43], s49 offen offset:1280
    buffer_load_dword v62, v6, s[40:43], s49 offen offset:2560
    buffer_load_dword v63, v6, s[40:43], s49 offen offset:3840
    buffer_load_dword v41, v4, s[36:39], 0 offen offset:2560 sc1
    s_mov_b32 s40, s30
    s_mov_b32 s41, s31
    s_waitcnt vmcnt(18)
    s_mov_b32 s59, 0
L_st:
    v_xor_b32 v13, s6, v13
    v_xor_b32 v15, s6, v15
    v_or_b32 v13, v13, v15
    v_cmp_ne_u32 vcc, 0, v13
    s_nop 0
    s_cbranch_vccz L_st_ok
    buffer_load_dwordx2 v[12:13], v7, s[36:39], s57 offen sc1
    buffer_load_dwordx2 v[14:15], v7, s[36:39], s58 offen sc1
    s_add_u32 s59, s59, 1
    s_cmp_lt_u32 s59, 65536
    s_waitcnt vmcnt(0)
    s_cbranch_scc1 L_st
L_st_ok:
    v_and_b32 v13, s52, v12
    v_rcp_f32 v13, v13
    v_lshlrev_b32 v12, 16, v12
    v_and_b32 v15, s52, v14
    v_rcp_f32 v15, v15
    v_lshlrev_b32 v14, 16, v14
    v_mul_f32 v12, v12, v13
    v_mul_f32 v14, v14, v15
    ds_swizzle_b32 v16, v12 offset:24
    ds_swizzle_b32 v17, v13 offset:24
    ds_swizzle_b32 v18, v12 offset:56
    ds_swizzle_b32 v19, v13 offset:56
    ds_swizzle_b32 v20, v12 offset:88
    ds_swizzle_b32 v21, v13 offset:88
    ds_swizzle_b32 v22, v12 offset:120
    ds_swizzle_b32 v23, v13 offset:120
    ds_swizzle_b32 v24, v12 offset:152
    ds_swizzle_b32 v25, v13 offset:152
    ds_swizzle_b32 v26, v12 offset:184
    ds_swizzle_b32 v27, v13 offset:184
    ds_swizzle_b32 v28, v12 offset:216
    ds_swizzle_b32 v29, v13 offset:216
    s_waitcnt lgkmcnt(6)
    ds_swizzle_b32 v30, v12 offset:248
    ds_swizzle_b32 v31, v13 offset:248
    s_waitcnt vmcnt(9)
    v_lshlrev_b32 v80, 16, v48
    v_and_b32 v81, s52, v48
    v_lshlrev_b32 v82, 16, v49
    v_and_b32 v83, s52, v49
    v_lshlrev_b32 v84, 16, v50
    v_and_b32 v85, s52, v50
    v_lshlrev_b32 v86, 16, v51
    v_and_b32 v87, s52, v51
    v_lshlrev_b32 v88, 16, v52
    v_and_b32 v89, s52, v52
    v_lshlrev_b32 v90, 16, v53
    v_and_b32 v91, s52, v53
    v_lshlrev_b32 v92, 16, v54
    v_and_b32 v93, s52, v54
    v_lshlrev_b32 v94, 16, v55
    v_and_b32 v95, s52, v55
    s_waitcnt lgkmcnt(0)
    v_fma_f32 v64, v80, v17, -v16
    v_fma_f32 v65, v81, v17, -v16
    v_add_f32 v80, v80, v64
    v_add_f32 v81, v81, v65
    v_fma_f32 v66, v82, v19, -v18
    v_fma_f32 v67, v83, v19, -v18
    v_add_f32 v82, v82, v66
    v_add_f32 v83, v83, v67
    v_fma_f32 v68, v84, v21, -v20
    v_fma_f32 v69, v85, v21, -v20
    v_add_f32 v84, v84, v68
    v_add_f32 v85, v85, v69
    v_fma_f32 v70, v86, v23, -v22
    v_fma_f32 v71, v87, v23, -v22
    v_add_f32 v86, v86, v70
    v_add_f32 v87, v87, v71
    v_fma_f32 v72, v88, v25, -v24
    v_fma_f32 v73, v89, v25, -v24
    v_add_f32 v88, v88, v72
    v_add_f32 v89, v89, v73
    v_fma_f32 v74, v90, v27, -v26
    v_fma_f32 v75, v91, v27, -v26
    v_add_f32 v90, v90, v74
    v_add_f32 v91, v91, v75
    v_fma_f32 v76, v92, v29, -v28
    v_fma_f32 v77, v93, v29, -v28
    v_add_f32 v92, v92, v76
    v_add_f32 v93, v93, v77
    v_fma_f32 v78, v94, v31, -v30
    v_fma_f32 v79, v95, v31, -v30
    v_add_f32 v94, v94, v78
    v_add_f32 v95, v95, v79
    s_mov_b32 s59, 0
L_h2:
    v_xor_b32 v40, s6, v40
    v_cmp_ne_u32 vcc, 0, v40
    s_nop 0
    s_cbranch_vccz L_h2_ok
    buffer_load_dword v40, v46, s[36:39], s96 offen sc1
    s_add_u32 s59, s59, 1
    s_cmp_lt_u32 s59, 65536
    s_waitcnt vmcnt(0)
    s_cbranch_scc1 L_h2
L_h2_ok:
    buffer_load_dwordx4 v[32:35], v44, s[36:39], 0 offen offset:2560 sc1
    buffer_load_dword v42, v44, s[36:39], 0 offen offset:2544 sc1
    s_mov_b32 exec_lo, 0xffffffff
    s_mov_b32 exec_hi, 0x0
    buffer_load_dwordx4 v[36:39], v44, s[36:39], 0 offen offset:3584 sc1
    buffer_load_dword v43, v44, s[36:39], 0 offen offset:3568 sc1
    s_mov_b64 exec, -1
    buffer_load_dwordx2 v[10:11], v9, s[36:39], 0 offen sc1
    ds_swizzle_b32 v16, v14 offset:24
    ds_swizzle_b32 v17, v15 offset:24
    ds_swizzle_b32 v18, v14 offset:56
    ds_swizzle_b32 v19, v15 offset:56
    ds_swizzle_b32 v20, v14 offset:88
    ds_swizzle_b32 v21, v15 offset:88
    ds_swizzle_b32 v22, v14 offset:120
    ds_swizzle_b32 v23, v15 offset:120
    ds_swizzle_b32 v24, v14 offset:152
    ds_swizzle_b32 v25, v15 offset:152
    ds_swizzle_b32 v26, v14 offset:184
    ds_swizzle_b32 v27, v15 offset:184
    ds_swizzle_b32 v28, v14 offset:216
    ds_swizzle_b32 v29, v15 offset:216
    s_waitcnt lgkmcnt(6)
    ds_swizzle_b32 v30, v14 offset:248
    ds_swizzle_b32 v31, v15 offset:248
    s_waitcnt vmcnt(6)
    v_lshlrev_b32 v112, 16, v56
    v_and_b32 v113, s52, v56
    v_lshlrev_b32 v114, 16, v57
    v_and_b32 v115, s52, v57
    v_lshlrev_b32 v116, 16, v58
    v_and_b32 v117, s52, v58
    v_lshlrev_b32 v118, 16, v59
    v_and_b32 v119, s52, v59
    v_lshlrev_b32 v120, 16, v60
    v_and_b32 v121, s52, v60
    v_lshlrev_b32 v122, 16, v61
    v_and_b32 v123, s52, v61
    v_lshlrev_b32 v124, 16, v62
    v_and_b32 v125, s52, v62
    v_lshlrev_b32 v126, 16, v63
    v_and_b32 v127, s52, v63
    s_waitcnt lgkmcnt(0)
    v_fma_f32 v96, v112, v17, -v16
    v_fma_f32 v97, v113, v17, -v16
    v_add_f32 v112, v112, v96
    v_add_f32 v113, v113, v97
    v_fma_f32 v98, v114, v19, -v18
    v_fma_f32 v99, v115, v19, -v18
    v_add_f32 v114, v114, v98
    v_add_f32 v115, v115, v99
    v_fma_f32 v100, v116, v21, -v20
    v_fma_f32 v101, v117, v21, -v20
    v_add_f32 v116, v116, v100
    v_add_f32 v117, v117, v101
    v_fma_f32 v102, v118, v23, -v22
    v_fma_f32 v103, v119, v23, -v22
    v_add_f32 v118, v118, v102
    v_add_f32 v119, v119, v103
    v_fma_f32 v104, v120, v25, -v24
    v_fma_f32 v105, v121, v25, -v24
    v_add_f32 v120, v120, v104
    v_add_f32 v121, v121, v105
    v_fma_f32 v106, v122, v27, -v26
    v_fma_f32 v107, v123, v27, -v26
    v_add_f32 v122, v122, v106
    v_add_f32 v123, v123, v107
    v_fma_f32 v108, v124, v29, -v28
    v_fma_f32 v109, v125, v29, -v28
    v_add_f32 v124, v124, v108
    v_add_f32 v125, v125, v109
    v_fma_f32 v110, v126, v31, -v30
    v_fma_f32 v111, v127, v31, -v30
    v_add_f32 v126, v126, v110
    v_add_f32 v127, v127, v111
    v_mov_b32 v12, -1
    v_mov_b32 v13, -1
    v_mov_b32 v14, -1
    v_mov_b32 v15, -1
    s_sub_u32 s56, s51, 1048576
    s_lshl_b32 s54, s4, 4
    s_lshl_b32 s55, s5, 2
    s_add_u32 s54, s54, s55
    v_mov_b32 v30, s54
    v_mov_b32 v31, s6
    s_waitcnt vmcnt(3)
    ds_write_b128 v45, v[32:35] offset:7136
    v_alignbyte_b32 v16, v33, v32, 2
    v_alignbyte_b32 v17, v34, v33, 2
    v_alignbyte_b32 v18, v35, v34, 2
    v_alignbyte_b32 v19, v42, v35, 2
    ds_write_b128 v45, v[16:19] offset:2560
    s_waitcnt vmcnt(1)
    s_mov_b32 exec_lo, 0xffffffff
    s_mov_b32 exec_hi, 0x0
    ds_write_b128 v45, v[36:39] offset:8160
    v_alignbyte_b32 v20, v37, v36, 2
    v_alignbyte_b32 v21, v38, v37, 2
    v_alignbyte_b32 v22, v39, v38, 2
    v_alignbyte_b32 v23, v43, v39, 2
    ds_write_b128 v45, v[20:23] offset:3584
    s_mov_b64 exec, -1
    ds_write_b32 v47, v47
    s_cmp_lg_u32 s51, 1048576
    s_cbranch_scc1 L_sslow
    buffer_store_dwordx4 v[12:15], v44, s[36:39], s56 offen offset:2048
    buffer_store_dwordx4 v[12:15], v44, s[36:39], s56 offen offset:3072
    buffer_load_dwordx2 v[42:43], v3, s[36:39], s61 offen sc1
    s_waitcnt vmcnt(0)
    s_mov_b64 exec, 0x1
    buffer_store_dword v31, v30, s[36:39], s61 offen offset:1024
L_sback:
    s_mov_b64 exec, -1
    ds_write_b32 v47, v47 offset:16
    s_mov_b32 s59, 0
L_h3:
    v_xor_b32 v42, s6, v42
    v_xor_b32 v43, s6, v43
    v_or_b32 v42, v42, v43
    v_cmp_ne_u32 vcc, 0, v42
    s_nop 0
    s_cbranch_vccz L_h3_ok
    buffer_load_dwordx2 v[42:43], v3, s[36:39], s61 offen sc1
    s_add_u32 s59, s59, 1
    s_cmp_lt_u32 s59, 65536
    s_waitcnt vmcnt(0)
    s_cbranch_scc1 L_h3
L_h3_ok:
    buffer_load_dwordx4 v[48:51], v8, s[36:39], s60 offen offset:0 sc1
    buffer_load_dwordx4 v[52:55], v8, s[36:39], s48 offen offset:0 sc1
    s_mov_b32 s59, 0
L_tp:
    v_xor_b32 v11, s6, v11
    v_cmp_ne_u32 vcc, 0, v11
    s_nop 0
    s_cbranch_vccz L_tp_ok
    buffer_load_dwordx2 v[10:11], v9, s[36:39], 0 offen sc1
    s_add_u32 s59, s59, 1
    s_cmp_lt_u32 s59, 65536
    s_waitcnt vmcnt(0)
    s_cbranch_scc1 L_tp
L_tp_ok:
    v_readfirstlane_b32 s62, v10
    s_nop 0
    s_lshr_b32 s63, s62, 16
    s_and_b32 s62, s62, 0xffff
    s_lshr_b32 s56, s62, 3
    s_lshr_b32 s57, s63, 3
    v_cmp_eq_u32 s[44:45], s56, v1
    v_cmp_eq_u32 s[46:47], s57, v1
    s_waitcnt vmcnt(0)
    v_lshlrev_b32 v56, 16, v48
    v_and_b32 v57, s52, v48
    v_lshlrev_b32 v58, 16, v49
    v_and_b32 v59, s52, v49
    v_lshlrev_b32 v60, 16, v50
    v_and_b32 v61, s52, v50
    v_lshlrev_b32 v62, 16, v51
    v_and_b32 v63, s52, v51
    v_fmac_f32 v80, v64, v56
    v_fmac_f32 v84, v68, v57
    v_fmac_f32 v88, v72, v58
    v_fmac_f32 v92, v76, v59
    v_fmac_f32 v82, v66, v60
    v_fmac_f32 v86, v70, v61
    v_fmac_f32 v90, v74, v62
    v_fmac_f32 v94, v78, v63
    v_lshlrev_b32 v56, 16, v52
    v_and_b32 v57, s52, v52
    v_lshlrev_b32 v58, 16, v53
    v_and_b32 v59, s52, v53
    v_lshlrev_b32 v60, 16, v54
    v_and_b32 v61, s52, v54
    v_lshlrev_b32 v62, 16, v55
    v_and_b32 v63, s52, v55
    v_fmac_f32 v81, v65, v56
    v_fmac_f32 v85, v69, v57
    v_fmac_f32 v89, v73, v58
    v_fmac_f32 v93, v77, v59
    v_fmac_f32 v83, v67, v60
    v_fmac_f32 v87, v71, v61
    v_fmac_f32 v91, v75, v62
    v_fmac_f32 v95, v79, v63
    v_cvt_pk_bf16_f32 v48, v80, v81
    v_cvt_pk_bf16_f32 v49, v82, v83
    v_cvt_pk_bf16_f32 v50, v84, v85
    v_cvt_pk_bf16_f32 v51, v86, v87
    v_cvt_pk_bf16_f32 v52, v88, v89
    v_cvt_pk_bf16_f32 v53, v90, v91
    v_cvt_pk_bf16_f32 v54, v92, v93
    v_cvt_pk_bf16_f32 v55, v94, v95
    s_or_b64 s[54:55], s[44:45], s[46:47]
    s_cbranch_scc1 L_msk0
    buffer_store_dword v48, v5, s[40:43], 0 offen offset:0
    buffer_store_dword v49, v5, s[40:43], 0 offen offset:1280
    buffer_store_dword v50, v5, s[40:43], 0 offen offset:2560
    buffer_store_dword v51, v5, s[40:43], 0 offen offset:3840
    buffer_store_dword v52, v5, s[40:43], s49 offen offset:0
    buffer_store_dword v53, v5, s[40:43], s49 offen offset:1280
    buffer_store_dword v54, v5, s[40:43], s49 offen offset:2560
    buffer_store_dword v55, v5, s[40:43], s49 offen offset:3840
L_mskd0:
    s_lshr_b32 s56, s62, 3
    s_lshr_b32 s57, s63, 3
    v_cmp_eq_u32 s[44:45], s56, v2
    v_cmp_eq_u32 s[46:47], s57, v2
    s_add_u32 s57, s61, 1024
    s_mov_b32 s59, 0
L_yfs:
    buffer_load_dwordx2 v[10:11], v3, s[36:39], s57 offen sc1
    s_add_u32 s59, s59, 1
    s_waitcnt vmcnt(0)
    v_cmp_ne_u32 vcc, s6, v10
    v_cmp_ne_u32 s[54:55], s6, v11
    s_nop 0
    s_or_b64 vcc, vcc, s[54:55]
    s_cbranch_scc0 L_yfs_ok
    s_cmp_lt_u32 s59, 65536
    s_cbranch_scc1 L_yfs
L_yfs_ok:
    s_barrier
    s_mov_b32 s59, 0
L_ys:
    buffer_load_dwordx4 v[48:51], v8, s[36:39], s60 offen offset:2048 sc1
    buffer_load_dwordx4 v[52:55], v8, s[36:39], s48 offen offset:2048 sc1
    s_add_u32 s59, s59, 1
    s_waitcnt vmcnt(0)
    v_max3_u32 v24, v48, v49, v50
    v_max3_u32 v25, v51, v52, v53
    v_max3_u32 v24, v24, v54, v55
    v_max_u32 v24, v24, v25
    v_cmp_eq_u32 vcc, -1, v24
    s_nop 0
    s_and_b64 exec, exec, vcc
    s_cbranch_execz L_ysok
    s_cmp_lt_u32 s59, 4096
    s_cbranch_scc1 L_ys
    s_mov_b64 exec, -1
    s_add_u32 s61, s61, 512
    s_mov_b32 s59, 0
L_yf1:
    buffer_load_dwordx2 v[10:11], v3, s[36:39], s61 offen sc1
    s_add_u32 s59, s59, 1
    s_waitcnt vmcnt(0)
    v_cmp_ne_u32 vcc, s6, v10
    v_cmp_ne_u32 s[54:55], s6, v11
    s_nop 0
    s_or_b64 vcc, vcc, s[54:55]
    s_cbranch_scc0 L_yf1_ok
    s_cmp_lt_u32 s59, 65536
    s_cbranch_scc1 L_yf1
L_yf1_ok:
    buffer_load_dwordx4 v[48:51], v8, s[36:39], s60 offen offset:2048 sc1
    buffer_load_dwordx4 v[52:55], v8, s[36:39], s48 offen offset:2048 sc1
    s_waitcnt vmcnt(0)
L_ysok:
    s_mov_b64 exec, -1
    v_lshlrev_b32 v56, 16, v48
    v_and_b32 v57, s52, v48
    v_lshlrev_b32 v58, 16, v49
    v_and_b32 v59, s52, v49
    v_lshlrev_b32 v60, 16, v50
    v_and_b32 v61, s52, v50
    v_lshlrev_b32 v62, 16, v51
    v_and_b32 v63, s52, v51
    v_fmac_f32 v112, v96, v56
    v_fmac_f32 v116, v100, v57
    v_fmac_f32 v120, v104, v58
    v_fmac_f32 v124, v108, v59
    v_fmac_f32 v114, v98, v60
    v_fmac_f32 v118, v102, v61
    v_fmac_f32 v122, v106, v62
    v_fmac_f32 v126, v110, v63
    v_lshlrev_b32 v56, 16, v52
    v_and_b32 v57, s52, v52
    v_lshlrev_b32 v58, 16, v53
    v_and_b32 v59, s52, v53
    v_lshlrev_b32 v60, 16, v54
    v_and_b32 v61, s52, v54
    v_lshlrev_b32 v62, 16, v55
    v_and_b32 v63, s52, v55
    v_fmac_f32 v113, v97, v56
    v_fmac_f32 v117, v101, v57
    v_fmac_f32 v121, v105, v58
    v_fmac_f32 v125, v109, v59
    v_fmac_f32 v115, v99, v60
    v_fmac_f32 v119, v103, v61
    v_fmac_f32 v123, v107, v62
    v_fmac_f32 v127, v111, v63
    v_cvt_pk_bf16_f32 v48, v112, v113
    v_cvt_pk_bf16_f32 v49, v114, v115
    v_cvt_pk_bf16_f32 v50, v116, v117
    v_cvt_pk_bf16_f32 v51, v118, v119
    v_cvt_pk_bf16_f32 v52, v120, v121
    v_cvt_pk_bf16_f32 v53, v122, v123
    v_cvt_pk_bf16_f32 v54, v124, v125
    v_cvt_pk_bf16_f32 v55, v126, v127
    s_or_b64 s[54:55], s[44:45], s[46:47]
    s_cbranch_scc1 L_msk1
    buffer_store_dword v48, v6, s[40:43], 0 offen offset:0
    buffer_store_dword v49, v6, s[40:43], 0 offen offset:1280
    buffer_store_dword v50, v6, s[40:43], 0 offen offset:2560
    buffer_store_dword v51, v6, s[40:43], 0 offen offset:3840
    buffer_store_dword v52, v6, s[40:43], s49 offen offset:0
    buffer_store_dword v53, v6, s[40:43], s49 offen offset:1280
    buffer_store_dword v54, v6, s[40:43], s49 offen offset:2560
    buffer_store_dword v55, v6, s[40:43], s49 offen offset:3840
L_mskd1:
    s_endpgm
L_special:
    s_and_b32 s96, s4, 1
    s_bfe_u32 s97, s4, 0x10001
    s_lshl_b32 s98, s96, 1
    s_add_u32 s98, s98, s97
    s_mul_i32 s98, s98, 320
    s_mul_i32 s55, s3, 1280
    s_add_u32 s98, s98, s55
    s_add_u32 s98, s98, 131072
    s_cmp_lg_u32 s5, 0
    s_cbranch_scc1 L_sp1
    v_min_u32 v6, 19, v0
    v_mul_u32_u24 v5, 52, v6
    v_lshrrev_b32 v5, 8, v5
    v_mul_u32_u24 v1, 5, v5
    v_sub_u32 v1, v6, v1
    v_lshlrev_b32 v1, 3, v1
    v_lshl_add_u32 v1, v5, 1, v1
    v_add_u32 v1, s97, v1
    v_lshlrev_b32 v6, 3, v6
    s_lshl_b32 s54, s3, 7
    s_add_u32 s54, s54, 40960
    v_mov_b32 v9, s54
    buffer_load_dwordx2 v[10:11], v9, s[36:39], 0 offen sc1
    s_waitcnt vmcnt(0)
    s_mov_b32 s59, 0
L_sc:
    v_xor_b32 v11, s6, v11
    v_cmp_ne_u32 vcc, 0, v11
    s_nop 0
    s_cbranch_vccz L_sc_ok
    buffer_load_dwordx2 v[10:11], v9, s[36:39], 0 offen sc1
    s_add_u32 s59, s59, 1
    s_cmp_lt_u32 s59, 65536
    s_waitcnt vmcnt(0)
    s_cbranch_scc1 L_sc
L_sc_ok:
    v_readfirstlane_b32 s62, v10
    s_lshl_b32 s54, s96, 4
    s_lshr_b32 s62, s62, s54
    s_and_b32 s62, s62, 0x7ff
    s_mov_b32 s40, s8
    s_mov_b32 s41, s9
    s_mov_b32 s42, 0x280000
    s_mov_b32 s43, 0x20000
    s_mul_i32 s54, s62, 1280
    s_mul_i32 s55, s3, 160
    s_add_u32 s54, s54, s55
    v_lshl_add_u32 v2, v1, 2, s54
    buffer_load_dword v4, v2, s[40:43], 0 offen
    s_lshl_b32 s54, s62, 3
    s_add_u32 s54, s54, 98304
    v_mov_b32 v3, s54
    buffer_load_dwordx2 v[8:9], v3, s[36:39], 0 offen sc1
    s_waitcnt vmcnt(0)
    s_mov_b32 s59, 0
L_ss:
    v_xor_b32 v9, s6, v9
    v_cmp_ne_u32 vcc, 0, v9
    s_nop 0
    s_cbranch_vccz L_ss_ok
    buffer_load_dwordx2 v[8:9], v3, s[36:39], 0 offen sc1
    s_add_u32 s59, s59, 1
    s_cmp_lt_u32 s59, 65536
    s_waitcnt vmcnt(0)
    s_cbranch_scc1 L_ss
L_ss_ok:
    v_and_b32 v9, s52, v8
    v_rcp_f32 v9, v9
    v_lshlrev_b32 v8, 16, v8
    v_lshlrev_b32 v50, 16, v4
    v_and_b32 v51, s52, v4
    v_sub_f32 v48, v50, v8
    v_sub_f32 v49, v51, v8
    v_mul_f32 v48, v48, v9
    v_mul_f32 v49, v49, v9
    v_add_f32 v50, v50, v48
    v_add_f32 v51, v51, v49
    s_lshl_b32 s55, s3, 11
    s_add_u32 s61, s61, s55
    s_add_u32 s61, s61, 512
    s_mul_i32 s54, s3, 337920
    s_add_u32 s60, s60, s54
    s_lshr_b32 s54, s62, 3
    s_lshl_b32 s54, s54, 4
    s_add_u32 s60, s60, s54
    s_and_b32 s54, s62, 1
    s_lshl_b32 s54, s54, 3
    s_add_u32 s60, s60, s54
    s_and_b32 s54, s62, 4
    s_add_u32 s60, s60, s54
    s_add_u32 s48, s60, 4224
    s_bitcmp1_b32 s62, 1
    s_cselect_b32 s63, 0, 16
    v_lshlrev_b32 v3, 3, v1
    v_mul_u32_u24 v7, 8448, v1
    s_mov_b32 s40, s30
    s_mov_b32 s41, s31
    s_mov_b32 s42, 0x280000
    s_mov_b32 s43, 0x20000
    s_and_b32 s57, s62, 1024
    s_add_u32 s57, s57, s61
    s_mul_i32 s55, s3, 61440
    s_add_u32 s54, s98, s55
    v_mov_b32 v4, s54
    buffer_load_dwordx2 v[18:19], v3, s[36:39], s57 offen sc1
    buffer_load_dwordx2 v[16:17], v4, s[36:39], 0 offen sc1
    s_waitcnt vmcnt(0)
    s_mov_b32 s59, 0
L_p1:
    v_xor_b32 v17, s6, v17
    v_cmp_ne_u32 vcc, 0, v17
    s_nop 0
    s_cbranch_vccz L_p1_ok
    buffer_load_dwordx2 v[18:19], v3, s[36:39], s57 offen sc1
    buffer_load_dwordx2 v[16:17], v4, s[36:39], 0 offen sc1
    s_add_u32 s59, s59, 1
    s_cmp_lt_u32 s59, 65536
    s_waitcnt vmcnt(0)
    s_cbranch_scc1 L_p1
L_p1_ok:
    v_cmp_ne_u32 vcc, s6, v18
    v_cmp_ne_u32 s[54:55], s6, v19
    s_nop 0
    s_or_b64 vcc, vcc, s[54:55]
    s_cbranch_scc1 L_pfl
    buffer_load_dword v52, v7, s[36:39], s60 offen sc1
    buffer_load_dword v53, v7, s[36:39], s48 offen sc1
    s_barrier
    s_branch L_pfd
L_pfl:
    s_barrier
    s_mov_b32 s59, 0
L_s0:
    buffer_load_dwordx2 v[10:11], v3, s[36:39], s57 offen sc1
    s_add_u32 s59, s59, 1
    s_waitcnt vmcnt(0)
    v_cmp_ne_u32 vcc, s6, v10
    v_cmp_ne_u32 s[54:55], s6, v11
    s_nop 0
    s_or_b64 vcc, vcc, s[54:55]
    s_cbranch_scc0 L_s0_ok
    s_cmp_lt_u32 s59, 65536
    s_cbranch_scc1 L_s0
L_s0_ok:
    buffer_load_dword v52, v7, s[36:39], s60 offen sc1
    buffer_load_dword v53, v7, s[36:39], s48 offen sc1
L_pfd:
    s_barrier
    ds_read_b64 v[12:13], v6 offset:0
    ds_read_b64 v[14:15], v6 offset:160
    ds_read_b64 v[16:17], v6 offset:320
    ds_read_b64 v[18:19], v6 offset:512
    ds_read_b64 v[20:21], v6 offset:672
    ds_read_b64 v[22:23], v6 offset:832
    ds_read_b64 v[24:25], v6 offset:1024
    ds_read_b64 v[26:27], v6 offset:1184
    ds_read_b64 v[28:29], v6 offset:1344
    ds_read_b64 v[30:31], v6 offset:1536
    ds_read_b64 v[32:33], v6 offset:1696
    ds_read_b64 v[34:35], v6 offset:1856
    s_waitcnt lgkmcnt(6)
    v_add_f32 v12, v12, v14
    v_add_f32 v13, v13, v15
    v_add_f32 v12, v12, v16
    v_add_f32 v13, v13, v17
    v_add_f32 v12, v12, v18
    v_add_f32 v13, v13, v19
    v_add_f32 v12, v12, v20
    v_add_f32 v13, v13, v21
    v_add_f32 v12, v12, v22
    v_add_f32 v13, v13, v23
    ds_read_b64 v[36:37], v6 offset:2048
    ds_read_b64 v[38:39], v6 offset:2208
    ds_read_b64 v[40:41], v6 offset:2368
    ds_read_b64 v[42:43], v6 offset:2560
    ds_read_b64 v[44:45], v6 offset:2720
    ds_read_b64 v[46:47], v6 offset:2880
    v_add_f32 v50, v50, v12
    v_add_f32 v51, v51, v13
    s_waitcnt lgkmcnt(0)
    v_add_f32 v24, v24, v26
    v_add_f32 v25, v25, v27
    v_add_f32 v36, v36, v38
    v_add_f32 v37, v37, v39
    v_add_f32 v24, v24, v28
    v_add_f32 v25, v25, v29
    v_add_f32 v36, v36, v40
    v_add_f32 v37, v37, v41
    v_add_f32 v24, v24, v30
    v_add_f32 v25, v25, v31
    v_add_f32 v36, v36, v42
    v_add_f32 v37, v37, v43
    v_add_f32 v24, v24, v32
    v_add_f32 v25, v25, v33
    v_add_f32 v36, v36, v44
    v_add_f32 v37, v37, v45
    v_add_f32 v24, v24, v34
    v_add_f32 v25, v25, v35
    v_add_f32 v36, v36, v46
    v_add_f32 v37, v37, v47
    v_add_f32 v24, v24, v36
    v_add_f32 v25, v25, v37
    v_add_f32 v50, v50, v24
    v_add_f32 v51, v51, v25
    s_mov_b32 s59, 0
L_sy:
    s_waitcnt vmcnt(0)
    v_max_u32 v34, v52, v53
    v_cmp_eq_u32 vcc, -1, v34
    s_nop 0
    s_cbranch_vccz L_syok
    buffer_load_dword v52, v7, s[36:39], s60 offen sc1
    buffer_load_dword v53, v7, s[36:39], s48 offen sc1
    s_add_u32 s59, s59, 1
    s_cmp_lt_u32 s59, 4096
    s_cbranch_scc1 L_sy
    s_add_u32 s61, s61, 512
    s_mov_b32 s59, 0
L_s1:
    buffer_load_dwordx2 v[10:11], v3, s[36:39], s61 offen sc1
    s_add_u32 s59, s59, 1
    s_waitcnt vmcnt(0)
    v_cmp_ne_u32 vcc, s6, v10
    v_cmp_ne_u32 s[54:55], s6, v11
    s_nop 0
    s_or_b64 vcc, vcc, s[54:55]
    s_cbranch_scc0 L_s1_ok
    s_cmp_lt_u32 s59, 65536
    s_cbranch_scc1 L_s1
L_s1_ok:
    buffer_load_dword v52, v7, s[36:39], s60 offen sc1
    buffer_load_dword v53, v7, s[36:39], s48 offen sc1
    s_waitcnt vmcnt(0)
L_syok:
    v_lshlrev_b32 v32, s63, v52
    v_lshlrev_b32 v33, s63, v53
    v_and_b32 v32, s52, v32
    v_and_b32 v33, s52, v33
    v_fmac_f32 v50, v48, v32
    v_fmac_f32 v51, v49, v33
    v_cvt_pk_bf16_f32 v50, v50, v51
    buffer_store_dword v50, v2, s[40:43], 0 offen
    s_endpgm
L_sp1:
    v_min_u32 v4, 59, v0
    v_mul_u32_u24 v5, 103, v4
    v_lshrrev_b32 v5, 11, v5
    v_mul_u32_u24 v5, 9920, v5
    v_lshl_add_u32 v5, v4, 4, v5
    s_mul_i32 s55, s5, 92160
    s_add_u32 s55, s55, s98
    s_sub_u32 s55, s55, 92160
    s_add_u32 s56, s55, 30720
    s_add_u32 s57, s55, 61440
    s_barrier
    buffer_load_dwordx4 v[16:19], v5, s[36:39], s55 offen sc1
    buffer_load_dwordx4 v[20:23], v5, s[36:39], s56 offen sc1
    buffer_load_dwordx4 v[24:27], v5, s[36:39], s57 offen sc1
    s_waitcnt vmcnt(0)
    s_mov_b32 s59, 0
L_pp:
    v_xor_b32 v17, s6, v17
    v_xor_b32 v19, s6, v19
    v_xor_b32 v21, s6, v21
    v_xor_b32 v23, s6, v23
    v_xor_b32 v25, s6, v25
    v_xor_b32 v27, s6, v27
    v_or3_b32 v17, v17, v19, v21
    v_or3_b32 v23, v23, v25, v27
    v_or_b32 v17, v17, v23
    v_cmp_ne_u32 vcc, 0, v17
    s_nop 0
    s_cbranch_vccz L_pp_ok
    buffer_load_dwordx4 v[16:19], v5, s[36:39], s55 offen sc1
    buffer_load_dwordx4 v[20:23], v5, s[36:39], s56 offen sc1
    buffer_load_dwordx4 v[24:27], v5, s[36:39], s57 offen sc1
    s_add_u32 s59, s59, 1
    s_cmp_lt_u32 s59, 65536
    s_waitcnt vmcnt(0)
    s_cbranch_scc1 L_pp
L_pp_ok:
    v_add_f32 v16, v16, v20
    v_add_f32 v18, v18, v22
    v_add_f32 v16, v16, v24
    v_add_f32 v17, v18, v26
    s_lshl_b32 s54, s5, 9
    s_sub_u32 s54, s54, 512
    v_lshl_add_u32 v6, v0, 3, s54
    ds_write_b64 v6, v[16:17]
    s_waitcnt lgkmcnt(0)
    s_barrier
    s_endpgm
L_slowsync:
    v_min_u32 v4, 23, v0
    v_add_u32 v5, 8, v4
    v_cmp_gt_u32 vcc, 20, v4
    s_nop 1
    v_cndmask_b32 v4, v5, v4, vcc
    v_lshlrev_b32 v4, 10, v4
    s_lshl_b32 s57, s3, 7
    s_add_u32 s57, s57, 65536
    buffer_load_dwordx2 v[2:3], v4, s[36:39], s57 offen sc1
    s_waitcnt vmcnt(0)
    v_cmp_eq_u32 vcc, s6, v2
    v_cmp_ne_u32 s[56:57], s7, v3
    s_nop 0
    s_and_b64 vcc, vcc, s[56:57]
    s_cbranch_scc1 L_fb
    s_cmp_lt_u32 s59, 65536
    s_cbranch_scc1 L_poll
    s_branch L_synced
L_fb:
    s_mov_b32 s57, 20480
    s_mov_b32 s60, 9437184
    s_mov_b32 s61, 20480
    s_cmp_lg_u32 s5, 0
    s_cbranch_scc1 L_nowb
    buffer_wbl2 sc1
    s_waitcnt vmcnt(0)
    s_mov_b64 exec, 0x1
    buffer_store_dwordx2 v[10:11], v12, s[36:39], s57 offen sc1
    s_mov_b64 exec, -1
L_nowb:
    s_cmp_ge_u32 s4, 20
    s_cbranch_scc1 L_synced
    s_mov_b32 s59, 0
L_pollb:
    buffer_load_dwordx2 v[2:3], v1, s[36:39], s57 offen sc1
    s_add_u32 s59, s59, 1
    s_waitcnt vmcnt(0)
    v_cmp_eq_u32 vcc, s6, v2
    s_nop 0
    s_cmp_eq_u64 vcc, -1
    s_cbranch_scc1 L_bok
    s_sleep 2
    s_cmp_lt_u32 s59, 65536
    s_cbranch_scc1 L_pollb
L_bok:
    buffer_inv sc1
    s_waitcnt vmcnt(0)
    s_branch L_synced
L_s2wait:
    s_mov_b32 s59, 0
L_s2w:
    ds_read_b32 v14, v12 offset:0
    s_cselect_b32 s58, 1, 0
    s_add_u32 s59, s59, 1
    s_cmp_ge_u32 s59, 1048576
    s_cselect_b32 s54, 1, 0
    s_cmp_lg_u32 s58, 0
    s_waitcnt lgkmcnt(0)
    v_or_b32 v14, s54, v14
    v_cmp_eq_u32 vcc, 0, v14
    s_nop 0
    s_cbranch_vccnz L_s2w
    s_branch L_s2go
L_s3wait:
    s_mov_b32 s59, 0
L_s3w:
    ds_read_b32 v14, v12 offset:16
    s_cselect_b32 s58, 1, 0
    s_add_u32 s59, s59, 1
    s_cmp_ge_u32 s59, 1048576
    s_cselect_b32 s54, 1, 0
    s_cmp_lg_u32 s58, 0
    s_waitcnt lgkmcnt(0)
    v_or_b32 v14, s54, v14
    v_cmp_eq_u32 vcc, 0, v14
    s_nop 0
    s_cbranch_vccnz L_s3w
    s_branch L_s3go
L_ys0:
    buffer_store_dwordx2 v[96:97], v4, s[36:39], s56 offen offset:0 sc1
    s_branch L_yr0
L_ys1:
    buffer_store_dwordx2 v[100:101], v4, s[36:39], s56 offen offset:512 sc1
    s_branch L_yr1
L_ys2:
    buffer_store_dwordx2 v[104:105], v4, s[36:39], s56 offen offset:1024 sc1
    s_branch L_yr2
L_ys3:
    buffer_store_dwordx2 v[108:109], v4, s[36:39], s56 offen offset:1536 sc1
    s_branch L_yr3
L_ys4:
    buffer_store_dword v6, v5, s[36:39], s57 offen offset:512 sc1
    s_branch L_yr4
L_ys5:
    buffer_store_dwordx2 v[112:113], v4, s[36:39], s56 offen offset:2048 sc1
    s_branch L_yr5
L_ys6:
    buffer_store_dwordx2 v[116:117], v4, s[36:39], s56 offen offset:2560 sc1
    s_branch L_yr6
L_ys7:
    buffer_store_dwordx2 v[120:121], v4, s[36:39], s56 offen offset:3072 sc1
    s_branch L_yr7
L_ys8:
    buffer_store_dwordx2 v[124:125], v4, s[36:39], s56 offen offset:3584 sc1
    s_branch L_yr8
L_ys9:
    buffer_store_dword v6, v5, s[36:39], s57 offen offset:1024 sc1
    s_branch L_yr9
.p2align 12
L_lntail:
    s_waitcnt lgkmcnt(0)
    s_load_dword s6, s[34:35], 0
    s_mov_b32 s36, s34
    s_mov_b32 s37, s35
    s_mov_b32 s38, 0x1000000
    s_mov_b32 s39, 0x20000
    v_and_b32 v1, 7, v0
    v_bfe_u32 v2, v0, 3, 1
    v_lshrrev_b32 v3, 4, v0
    v_mul_u32_u24 v4, 1280, v1
    v_mul_u32_u24 v5, 640, v2
    v_add_u32 v4, v4, v5
    v_lshl_add_u32 v4, v3, 4, v4
    v_add_u32 v4, 140032, v4
    v_and_b32 v5, 15, v0
    v_cmp_lt_u32 vcc, 1, v5
    v_mov_b32 v6, 640
    s_nop 0
    v_cndmask_b32 v6, 0, v6, vcc
    v_lshl_add_u32 v6, v3, 4, v6
    v_add_u32 v6, 150272, v6
    s_mov_b32 s55, 0x3f803f80
    v_mov_b32 v56, s55
    v_mov_b32 v57, s55
    v_mov_b32 v58, s55
    v_mov_b32 v59, s55
    v_mov_b32 v60, s55
    v_mov_b32 v61, s55
    v_mov_b32 v62, s55
    v_mov_b32 v63, s55
    v_mov_b32 v64, s55
    v_mov_b32 v65, s55
    v_mov_b32 v66, s55
    v_mov_b32 v67, s55
    v_mov_b32 v68, s55
    v_mov_b32 v69, s55
    v_mov_b32 v70, s55
    v_mov_b32 v71, s55
    v_mov_b32 v72, s55
    v_mov_b32 v73, s55
    v_mov_b32 v74, s55
    v_mov_b32 v75, s55
    v_mov_b32 v76, s55
    v_mov_b32 v77, s55
    v_mov_b32 v78, s55
    v_mov_b32 v79, s55
    v_mov_b32 v80, s55
    v_mov_b32 v81, s55
    v_mov_b32 v82, s55
    v_mov_b32 v83, s55
    v_mov_b32 v84, s55
    v_mov_b32 v85, s55
    v_mov_b32 v86, s55
    v_mov_b32 v87, s55
    v_mov_b32 v88, s55
    v_mov_b32 v89, s55
    v_mov_b32 v90, s55
    v_mov_b32 v91, s55
    v_mov_b32 v92, s55
    v_mov_b32 v93, s55
    v_mov_b32 v94, s55
    v_mov_b32 v95, s55
    v_mov_b32 v96, s55
    v_mov_b32 v97, s55
    v_mov_b32 v98, s55
    v_mov_b32 v99, s55
    v_lshrrev_b32 v7, 2, v5
    v_lshl_add_u32 v7, v7, 4, v5
    v_lshlrev_b32 v7, 2, v7
    s_lshl_b32 s55, s99, 6
    s_add_u32 s55, s55, 98304
    v_lshl_add_u32 v122, v1, 3, s55
    s_lshl_b32 s56, s99, 3
    s_sub_u32 s56, 2047, s56
    v_sub_u32 v9, s56, v1
    s_mov_b32 s40, 0x22222222
    s_mov_b32 s41, 0x22222222
    s_mov_b32 s42, 0x44444444
    s_mov_b32 s43, 0x44444444
    s_mov_b32 s44, 0x88888888
    s_mov_b32 s45, 0x88888888
    s_mov_b32 s46, 0xff00ff00
    s_mov_b32 s47, 0xff00ff00
    s_mov_b32 s48, 0x60006
    s_mov_b32 s49, 0x60006
    s_lshl_b32 s55, s99, 4
    s_add_u32 s55, s55, 36864
    v_mov_b32 v8, s55
    s_waitcnt lgkmcnt(0)
    s_mul_i32 s6, s6, 0x9E3779B1
    s_add_u32 s6, s6, 0x7F4A7C15
    s_waitcnt vmcnt(0)
    ds_read_b128 v[16:19], v4 offset:0
    ds_read_b128 v[20:23], v4 offset:64
    ds_read_b128 v[24:27], v4 offset:128
    ds_read_b128 v[28:31], v4 offset:192
    ds_read_b128 v[32:35], v4 offset:256
    ds_read_b128 v[36:39], v4 offset:320
    ds_read_b128 v[40:43], v4 offset:384
    ds_read_b128 v[44:47], v4 offset:448
    ds_read_b128 v[48:51], v4 offset:512
    ds_read_b128 v[52:55], v4 offset:576
    s_waitcnt lgkmcnt(9)
    v_mfma_f32_16x16x32_bf16 v[100:103], v[16:19], v[16:19], 0
    s_mov_b64 exec, s[48:49]
    ds_read_b128 v[56:59], v6 offset:0
    s_mov_b64 exec, -1
    s_waitcnt lgkmcnt(9)
    v_mfma_f32_16x16x32_bf16 v[100:103], v[20:23], v[20:23], v[100:103]
    s_mov_b64 exec, s[48:49]
    ds_read_b128 v[60:63], v6 offset:64
    s_mov_b64 exec, -1
    s_waitcnt lgkmcnt(9)
    v_mfma_f32_16x16x32_bf16 v[100:103], v[24:27], v[24:27], v[100:103]
    s_mov_b64 exec, s[48:49]
    ds_read_b128 v[64:67], v6 offset:128
    s_mov_b64 exec, -1
    s_waitcnt lgkmcnt(9)
    v_mfma_f32_16x16x32_bf16 v[100:103], v[28:31], v[28:31], v[100:103]
    s_mov_b64 exec, s[48:49]
    ds_read_b128 v[68:71], v6 offset:192
    s_mov_b64 exec, -1
    s_waitcnt lgkmcnt(9)
    v_mfma_f32_16x16x32_bf16 v[100:103], v[32:35], v[32:35], v[100:103]
    s_mov_b64 exec, s[48:49]
    ds_read_b128 v[72:75], v6 offset:256
    s_mov_b64 exec, -1
    s_waitcnt lgkmcnt(9)
    v_mfma_f32_16x16x32_bf16 v[100:103], v[36:39], v[36:39], v[100:103]
    s_mov_b64 exec, s[48:49]
    ds_read_b128 v[76:79], v6 offset:320
    s_mov_b64 exec, -1
    s_waitcnt lgkmcnt(9)
    v_mfma_f32_16x16x32_bf16 v[100:103], v[40:43], v[40:43], v[100:103]
    s_mov_b64 exec, s[48:49]
    ds_read_b128 v[80:83], v6 offset:384
    s_mov_b64 exec, -1
    s_waitcnt lgkmcnt(9)
    v_mfma_f32_16x16x32_bf16 v[100:103], v[44:47], v[44:47], v[100:103]
    s_mov_b64 exec, s[48:49]
    ds_read_b128 v[84:87], v6 offset:448
    s_mov_b64 exec, -1
    s_waitcnt lgkmcnt(9)
    v_mfma_f32_16x16x32_bf16 v[100:103], v[48:51], v[48:51], v[100:103]
    s_mov_b64 exec, s[48:49]
    ds_read_b128 v[88:91], v6 offset:512
    s_mov_b64 exec, -1
    s_waitcnt lgkmcnt(9)
    v_mfma_f32_16x16x32_bf16 v[100:103], v[52:55], v[52:55], v[100:103]
    s_mov_b64 exec, s[48:49]
    ds_read_b128 v[92:95], v6 offset:576
    s_mov_b64 exec, -1
    s_waitcnt lgkmcnt(9)
    v_mfma_f32_16x16x32_bf16 v[104:107], v[56:59], v[16:19], 0
    v_mfma_f32_16x16x32_bf16 v[108:111], v[56:59], v[96:99], 0
    s_waitcnt lgkmcnt(8)
    v_mfma_f32_16x16x32_bf16 v[104:107], v[60:63], v[20:23], v[104:107]
    v_mfma_f32_16x16x32_bf16 v[108:111], v[60:63], v[96:99], v[108:111]
    s_waitcnt lgkmcnt(7)
    v_mfma_f32_16x16x32_bf16 v[104:107], v[64:67], v[24:27], v[104:107]
    v_mfma_f32_16x16x32_bf16 v[108:111], v[64:67], v[96:99], v[108:111]
    s_waitcnt lgkmcnt(6)
    v_mfma_f32_16x16x32_bf16 v[104:107], v[68:71], v[28:31], v[104:107]
    v_mfma_f32_16x16x32_bf16 v[108:111], v[68:71], v[96:99], v[108:111]
    v_cndmask_b32 v100, v100, v101, s[40:41]
    v_cndmask_b32 v100, v100, v102, s[42:43]
    v_cndmask_b32 v100, v100, v103, s[44:45]
    ds_bpermute_b32 v100, v7, v100
    s_waitcnt lgkmcnt(6)
    v_mfma_f32_16x16x32_bf16 v[104:107], v[72:75], v[32:35], v[104:107]
    v_mfma_f32_16x16x32_bf16 v[108:111], v[72:75], v[96:99], v[108:111]
    s_waitcnt lgkmcnt(5)
    v_mfma_f32_16x16x32_bf16 v[104:107], v[76:79], v[36:39], v[104:107]
    v_mfma_f32_16x16x32_bf16 v[108:111], v[76:79], v[96:99], v[108:111]
    s_waitcnt lgkmcnt(4)
    v_mfma_f32_16x16x32_bf16 v[104:107], v[80:83], v[40:43], v[104:107]
    v_mfma_f32_16x16x32_bf16 v[108:111], v[80:83], v[96:99], v[108:111]
    s_waitcnt lgkmcnt(3)
    v_mfma_f32_16x16x32_bf16 v[104:107], v[84:87], v[44:47], v[104:107]
    v_mfma_f32_16x16x32_bf16 v[108:111], v[84:87], v[96:99], v[108:111]
    s_waitcnt lgkmcnt(2)
    v_mfma_f32_16x16x32_bf16 v[104:107], v[88:91], v[48:51], v[104:107]
    v_mfma_f32_16x16x32_bf16 v[108:111], v[88:91], v[96:99], v[108:111]
    s_waitcnt lgkmcnt(1)
    v_mfma_f32_16x16x32_bf16 v[104:107], v[92:95], v[52:55], v[104:107]
    v_mfma_f32_16x16x32_bf16 v[108:111], v[92:95], v[96:99], v[108:111]
    s_waitcnt lgkmcnt(0)
    v_add_f32_dpp v100, v100, v100 row_ror:8 row_mask:0xf bank_mask:0xf
    v_mul_f32 v100, 0x3acccccd, v100
    v_mov_b32 v121, s6
    v_mov_b32 v14, 0
    s_nop 1
    v_add_f32_dpp v104, v104, v104 row_ror:8 row_mask:0xf bank_mask:0xf
    v_cndmask_b32 v105, v105, v106, s[46:47]
    v_mul_f32 v104, 0x3acccccd, v104
    v_add_f32 v109, v109, v110
    v_fma_f32 v100, -v104, v104, v100
    v_add_f32_dpp v105, v105, v105 row_ror:8 row_mask:0xf bank_mask:0xf
    v_max_f32 v100, 0, v100
    v_cvt_pk_bf16_f32 v104, v104, v100
    v_and_b32 v100, s52, v104
    v_add_f32 v100, 0x3727c5ac, v100
    v_cvt_pk_bf16_f32 v100, v100, v100
    v_and_b32 v100, s52, v100
    v_sqrt_f32 v100, v100
    v_lshlrev_b32 v106, 16, v104
    v_cvt_pk_bf16_f32 v120, v106, v100
    v_and_b32 v100, s52, v120
    v_rcp_f32 v100, v100
    v_fma_f32 v105, -v106, v109, v105
    v_mul_f32 v105, v105, v100
    v_cvt_pk_bf16_f32 v105, v105, v105
    v_ashrrev_i32 v106, 31, v105
    v_or_b32 v106, 0x80000000, v106
    v_xor_b32 v105, v105, v106
    v_and_or_b32 v12, v105, s52, v9
    s_nop 1
    v_min_u32_dpp v13, v12, v12 row_ror:1 row_mask:0xf bank_mask:0xf
    v_max_u32_dpp v15, v14, v14 row_ror:1 row_mask:0xf bank_mask:0xf
    v_max_u32_dpp v12, v12, v12 row_ror:1 row_mask:0xf bank_mask:0xf
    v_max_u32 v14, v13, v15
    s_nop 0
    v_min_u32_dpp v13, v12, v12 row_ror:2 row_mask:0xf bank_mask:0xf
    v_max_u32_dpp v15, v14, v14 row_ror:2 row_mask:0xf bank_mask:0xf
    v_max_u32_dpp v12, v12, v12 row_ror:2 row_mask:0xf bank_mask:0xf
    v_max_u32 v14, v13, v15
    s_nop 0
    v_min_u32_dpp v13, v12, v12 row_ror:4 row_mask:0xf bank_mask:0xf
    v_max_u32_dpp v15, v14, v14 row_ror:4 row_mask:0xf bank_mask:0xf
    v_max_u32_dpp v12, v12, v12 row_ror:4 row_mask:0xf bank_mask:0xf
    v_max_u32 v14, v13, v15
    v_mov_b32 v13, s6
    v_mov_b32 v15, s6
    s_mov_b64 exec, 0x1
    buffer_store_dwordx4 v[12:15], v8, s[36:39], 0 offen sc1
    s_mov_b64 exec, 0xff
    buffer_store_dwordx2 v[120:121], v122, s[36:39], 0 offen sc1
    s_mov_b64 exec, -1
    s_cmp_lt_u32 s63, 8
    s_cbranch_scc1 L_moe0
    s_cmp_ge_u32 s4, 20
    s_cbranch_scc1 L_h0
    s_lshl_b32 s54, s53, 14
    s_mul_i32 s55, s53, 16896
    s_add_u32 s55, s55, 1048576
    v_and_b32 v2, 31, v0
    v_min_u32 v2, 19, v2
    v_lshl_add_u32 v2, v2, 7, s55
    v_lshrrev_b32 v3, 5, v0
    v_mul_u32_u24 v3, 4224, v3
    v_add_u32 v2, v2, v3
    s_lshl_b32 s55, s3, 11
    s_add_u32 s55, s55, 4096
    v_and_b32 v3, 15, v0
    v_lshl_add_u32 v3, v3, 7, s55
    s_movk_i32 s55, 8448
    buffer_load_dword v127, v2, s[36:39], 0 offen sc1
    buffer_load_dword v127, v2, s[36:39], s55 offen sc1
    s_mov_b32 s48, s16
    s_mov_b32 s49, s17
    s_mov_b32 s50, 0x280000
    s_mov_b32 s51, 0x20000
    v_lshlrev_b32 v2, 4, v0
    s_mov_b32 m0, 12528
    s_nop 0
    buffer_load_dwordx4 v2, s[48:51], s54 offen offset:0 lds
    buffer_load_dwordx4 v2, s[48:51], s54 offen offset:1024 lds
    buffer_load_dwordx4 v2, s[48:51], s54 offen offset:2048 lds
    buffer_load_dwordx4 v2, s[48:51], s54 offen offset:3072 lds
    s_add_u32 s54, s54, 4096
    s_mov_b32 m0, 29168
    s_nop 0
    buffer_load_dwordx4 v2, s[48:51], s54 offen offset:0 lds
    buffer_load_dwordx4 v2, s[48:51], s54 offen offset:1024 lds
    buffer_load_dwordx4 v2, s[48:51], s54 offen offset:2048 lds
    buffer_load_dwordx4 v2, s[48:51], s54 offen offset:3072 lds
    s_add_u32 s54, s54, 4096
    s_mov_b32 m0, 45808
    s_nop 0
    buffer_load_dwordx4 v2, s[48:51], s54 offen offset:0 lds
    buffer_load_dwordx4 v2, s[48:51], s54 offen offset:1024 lds
    buffer_load_dwordx4 v2, s[48:51], s54 offen offset:2048 lds
    buffer_load_dwordx4 v2, s[48:51], s54 offen offset:3072 lds
    s_add_u32 s54, s54, 4096
    s_mov_b32 m0, 62448
    s_nop 0
    buffer_load_dwordx4 v2, s[48:51], s54 offen offset:0 lds
    buffer_load_dwordx4 v2, s[48:51], s54 offen offset:1024 lds
    buffer_load_dwordx4 v2, s[48:51], s54 offen offset:2048 lds
    buffer_load_dwordx4 v2, s[48:51], s54 offen offset:3072 lds
    s_add_u32 s54, s54, 4096
L_b1:
    s_lshl_b32 s59, s2, 7
    s_add_u32 s59, s59, 65536
    v_mov_b32 v10, s6
    v_mov_b32 v11, s7
    v_mov_b32 v12, s59
    s_barrier
    s_mov_b64 exec, 0x1
    buffer_store_dwordx2 v[10:11], v12, s[36:39], 0 offen sc1
    s_mov_b64 exec, -1
    s_cmp_lt_u32 s4, 20
    s_cbranch_scc1 L_kvdone
    s_barrier
    s_branch L_kvdone
L_h0:
    s_lshl_b32 s55, s3, 11
    s_add_u32 s57, s55, 4096
    v_and_b32 v3, 15, v0
    v_lshl_add_u32 v3, v3, 7, s57
    buffer_load_dword v127, v3, s[36:39], 0 offen sc1
    s_lshl_b32 s57, s58, 3
    s_add_u32 s57, s57, s55
    s_add_u32 s57, s57, 4096
    v_mov_b32 v10, s6
    v_mov_b32 v11, s7
    v_mov_b32 v12, s57
    s_mov_b64 exec, 0x1
    buffer_store_dwordx2 v[10:11], v12, s[36:39], 0 offen
    s_mov_b64 exec, -1
    s_barrier
    s_branch L_b1
L_hi4:
    s_cmp_lt_u32 s4, 20
    s_cbranch_scc1 L_mfma
    s_cmp_lg_u32 s5, 7
    s_cbranch_scc1 L_special
    s_cmp_lg_u32 s2, 224
    s_cbranch_scc1 L_fin
    v_lshlrev_b32 v1, 7, v0
    s_mov_b32 s54, 65536
    s_mov_b32 s55, 73728
    s_mov_b32 s56, 81920
    s_mov_b32 s57, 90112
    s_sleep 8
    buffer_load_dword v6, v1, s[36:39], s54 offen sc1
    buffer_load_dword v7, v1, s[36:39], s55 offen sc1
    buffer_load_dword v8, v1, s[36:39], s56 offen sc1
    buffer_load_dword v9, v1, s[36:39], s57 offen sc1
    s_waitcnt vmcnt(0)
    s_mov_b32 s59, 0
L_ep:
    v_xor_b32 v6, s6, v6
    v_xor_b32 v7, s6, v7
    v_xor_b32 v8, s6, v8
    v_xor_b32 v9, s6, v9
    v_or3_b32 v6, v6, v7, v8
    v_or_b32 v6, v6, v9
    v_cmp_ne_u32 vcc, 0, v6
    s_nop 0
    s_cbranch_vccz L_ep_ok
    s_sleep 8
    buffer_load_dword v6, v1, s[36:39], s54 offen sc1
    buffer_load_dword v7, v1, s[36:39], s55 offen sc1
    buffer_load_dword v8, v1, s[36:39], s56 offen sc1
    buffer_load_dword v9, v1, s[36:39], s57 offen sc1
    s_add_u32 s59, s59, 1
    s_cmp_lt_u32 s59, 65536
    s_waitcnt vmcnt(0)
    s_cbranch_scc1 L_ep
L_ep_ok:
    v_mov_b32 v10, s6
    v_mov_b32 v11, 0
    s_mov_b64 exec, 0x1
    buffer_store_dword v10, v11, s[36:39], 0 offen sc1
    s_mov_b64 exec, -1
    s_endpgm
L_mfma:
    s_sub_u32 s53, s5, 4
    s_mul_i32 s54, s53, 16640
    v_lshl_add_u32 v8, v0, 4, s54
    s_bitcmp1_b32 s62, 0
    s_cselect_b32 s55, 0, 16
    s_lshl_b32 s55, s63, s55
    s_and_b32 s55, s55, s52
    ds_read_b128 v[16:19], v8 offset:12512
    ds_read_b128 v[20:23], v8 offset:12528
    ds_read_b128 v[32:35], v8 offset:13536
    ds_read_b128 v[36:39], v8 offset:13552
    ds_read_b128 v[48:51], v8 offset:14560
    ds_read_b128 v[52:55], v8 offset:14576
    ds_read_b128 v[64:67], v8 offset:15584
    ds_read_b128 v[68:71], v8 offset:15600
    s_waitcnt lgkmcnt(6)
    s_mov_b64 exec, 0x1
    v_lshlrev_b32 v9, 16, v20
    v_add_f32 v9, s55, v9
    v_and_b32 v10, s52, v20
    v_cvt_pk_bf16_f32 v20, v9, v10
    ds_write_b32 v8, v20 offset:12528
    s_mov_b64 exec, -1
    ds_write_b128 v8, v[18:21] offset:4208
    v_mov_b32 v24, v17
    v_mov_b32 v25, v18
    v_mov_b32 v26, v19
    v_mov_b32 v27, v20
    v_mov_b32 v28, v21
    v_mov_b32 v29, v22
    ds_write_b128 v8, v[24:27] offset:48
    ds_write_b128 v8, v[26:29] offset:8368
    s_waitcnt lgkmcnt(8)
    ds_write_b128 v8, v[34:37] offset:5232
    v_mov_b32 v40, v33
    v_mov_b32 v41, v34
    v_mov_b32 v42, v35
    v_mov_b32 v43, v36
    v_mov_b32 v44, v37
    v_mov_b32 v45, v38
    ds_write_b128 v8, v[40:43] offset:1072
    ds_write_b128 v8, v[42:45] offset:9392
    s_waitcnt lgkmcnt(9)
    ds_write_b128 v8, v[50:53] offset:6256
    v_mov_b32 v56, v49
    v_mov_b32 v57, v50
    v_mov_b32 v58, v51
    v_mov_b32 v59, v52
    v_mov_b32 v60, v53
    v_mov_b32 v61, v54
    ds_write_b128 v8, v[56:59] offset:2096
    ds_write_b128 v8, v[58:61] offset:10416
    s_waitcnt lgkmcnt(10)
    ds_write_b128 v8, v[66:69] offset:7280
    v_mov_b32 v72, v65
    v_mov_b32 v73, v66
    v_mov_b32 v74, v67
    v_mov_b32 v75, v68
    v_mov_b32 v76, v69
    v_mov_b32 v77, v70
    ds_write_b128 v8, v[72:75] offset:3120
    ds_write_b128 v8, v[74:77] offset:11440
    v_and_b32 v6, 3, v0
    v_mul_u32_u24 v1, 4160, v6
    v_bfe_u32 v6, v0, 2, 2
    v_lshrrev_b32 v7, 4, v0
    v_add_u32 v6, v6, v7
    v_lshl_add_u32 v1, v6, 4, v1
    v_add_u32 v1, s54, v1
    v_and_b32 v6, 1, v0
    v_mul_u32_u24 v2, 4576, v6
    v_bfe_u32 v6, v0, 1, 3
    v_lshlrev_b32 v6, 2, v6
    v_sub_u32 v6, v6, v7
    v_lshl_add_u32 v2, v6, 4, v2
    s_mul_i32 s54, s53, 9120
    s_add_u32 s54, s54, 66608
    v_add_u32 v2, s54, v2
    v_bfe_u32 v6, v0, 1, 3
    v_lshl_add_u32 v6, v6, 2, v7
    v_and_b32 v5, 1, v0
    v_lshlrev_b32 v4, 4, v6
    v_lshl_add_u32 v4, v5, 3, v4
    s_mul_i32 s54, s62, 4224
    v_add_u32 v4, s54, v4
    s_mul_i32 s54, s3, 1728
    s_lshl_b32 s55, s62, 2
    s_add_u32 s54, s54, s55
    v_mov_b32 v5, s54
    v_mov_b32 v6, s6
    v_mov_b32 v7, 139776
    s_lshl_b32 s54, s53, 2
    s_add_u32 s54, s54, 139792
    v_mov_b32 v12, s54
    v_mov_b32 v13, 0
    ds_write2_b32 v12, v13, v13 offset0:0 offset1:4
    s_mov_b32 s60, 1048576
    s_mov_b32 s61, 4096
    s_mov_b32 s56, 9437184
    s_mov_b32 s57, 20480
    s_waitcnt lgkmcnt(0)
    ds_read_b128 a[0:3], v1 offset:0
    ds_read_b128 a[4:7], v1 offset:512
    ds_read_b128 a[8:11], v1 offset:1024
    ds_read_b128 a[12:15], v1 offset:1536
    ds_read_b128 a[16:19], v1 offset:64
    ds_read_b128 a[20:23], v1 offset:576
    ds_read_b128 a[24:27], v1 offset:1088
    ds_read_b128 a[28:31], v1 offset:1600
    s_waitcnt lgkmcnt(7)
    ds_read_b128 a[32:35], v1 offset:128
    ds_read_b128 a[36:39], v1 offset:640
    ds_read_b128 a[40:43], v1 offset:1152
    ds_read_b128 a[44:47], v1 offset:1664
    ds_read_b128 a[48:51], v1 offset:192
    ds_read_b128 a[52:55], v1 offset:704
    ds_read_b128 a[56:59], v1 offset:1216
    ds_read_b128 a[60:63], v1 offset:1728
    s_waitcnt lgkmcnt(7)
    s_branch L_mbody
L_nonp1:
    v_lshrrev_b32 v1, 2, v0
    v_mul_u32_u24 v1, 3456, v1
    v_lshrrev_b32 v2, 4, v0
    v_and_b32 v2, 2, v2
    v_and_b32 v3, 3, v0
    v_xor_b32 v2, v2, v3
    v_lshl_add_u32 v100, v2, 4, v1
    s_cmp_lt_u32 s3, 3
    s_cselect_b32 s54, 8, 6
    s_cselect_b32 s55, 0, 6
    s_mul_i32 s56, s3, s54
    s_add_u32 s56, s56, s55
    s_add_u32 s53, s63, s56
    s_cmp_ge_u32 s63, s54
    s_cselect_b32 s58, 100, -1
    s_add_u32 s58, s58, s5
    s_mul_i32 s55, s58, 276480
    s_lshl_b32 s56, s53, 6
    s_add_u32 s55, s55, s56
    s_mul_i32 s54, s58, 5120
    s_bitcmp1_b32 s53, 0
    s_cselect_b32 s96, 20, 0
    s_mul_i32 s62, s96, 55296
    s_add_u32 s55, s55, s62
    s_lshl_b32 s57, s96, 10
    s_add_u32 s54, s54, s57
    s_lshl_b32 s96, s96, 1
    s_sub_u32 s96, 15, s96
    s_mul_i32 s62, s96, 55296
    s_lshl_b32 s96, s96, 10
    s_waitcnt lgkmcnt(0)
    s_load_dword s6, s[34:35], 0
    s_mov_b32 s36, s34
    s_mov_b32 s37, s35
    s_mov_b32 s38, 0x1000000
    s_mov_b32 s39, 0x20000
    s_mov_b32 s40, s24
    s_mov_b32 s41, s25
    s_mov_b32 s42, 0x21c000
    s_mov_b32 s43, 0x20000
    s_mov_b32 s44, s26
    s_mov_b32 s45, s27
    s_mov_b32 s46, 0x21c000
    s_mov_b32 s47, 0x20000
    s_mov_b32 s48, s28
    s_mov_b32 s49, s29
    s_mov_b32 s50, 0x21c000
    s_mov_b32 s51, 0x20000
    s_barrier
    s_mul_i32 s97, s53, 40960
    s_lshl_b32 s98, s58, 10
    s_cmp_ge_u32 s58, 4
    s_cbranch_scc1 L_noe
    s_add_u32 m0, s54, 0
    s_nop 0
    buffer_load_dwordx4 v100, s[40:43], s55 offen lds
    s_add_u32 m0, s54, 40976
    s_nop 0
    buffer_load_dwordx4 v100, s[44:47], s55 offen lds
    s_add_u32 s55, s55, 55296
L_noe:
    v_subrev_u32 v9, 64, v9
    v_add_u32 v1, 0, v9
    v_mul_u32_u24 v2, 1599, v1
    v_lshrrev_b32 v2, 17, v2
    v_mul_u32_u24 v3, 82, v2
    v_sub_u32 v1, v1, v3
    v_min_u32 v1, 79, v1
    v_mul_u32_u24 v2, 1280, v2
    v_lshl_add_u32 v101, v1, 4, v2
    v_add_u32 v1, 256, v9
    v_mul_u32_u24 v2, 1599, v1
    v_lshrrev_b32 v2, 17, v2
    v_mul_u32_u24 v3, 82, v2
    v_sub_u32 v1, v1, v3
    v_min_u32 v1, 79, v1
    v_mul_u32_u24 v2, 1280, v2
    v_lshl_add_u32 v102, v1, 4, v2
    v_add_u32 v1, 512, v9
    v_mul_u32_u24 v2, 1599, v1
    v_lshrrev_b32 v2, 17, v2
    v_mul_u32_u24 v3, 82, v2
    v_sub_u32 v1, v1, v3
    v_min_u32 v1, 79, v1
    v_mul_u32_u24 v2, 1280, v2
    v_lshl_add_u32 v103, v1, 4, v2
    v_add_u32 v1, 768, v9
    v_mul_u32_u24 v2, 1599, v1
    v_lshrrev_b32 v2, 17, v2
    v_mul_u32_u24 v3, 82, v2
    v_sub_u32 v1, v1, v3
    v_min_u32 v1, 79, v1
    v_mul_u32_u24 v2, 1280, v2
    v_lshl_add_u32 v104, v1, 4, v2
    v_add_u32 v1, 1024, v9
    v_mul_u32_u24 v2, 1599, v1
    v_lshrrev_b32 v2, 17, v2
    v_mul_u32_u24 v3, 82, v2
    v_sub_u32 v1, v1, v3
    v_min_u32 v1, 79, v1
    v_mul_u32_u24 v2, 1280, v2
    v_lshl_add_u32 v105, v1, 4, v2
    v_add_u32 v1, 1280, v9
    v_mul_u32_u24 v2, 1599, v1
    v_lshrrev_b32 v2, 17, v2
    v_mul_u32_u24 v3, 82, v2
    v_sub_u32 v1, v1, v3
    v_min_u32 v1, 79, v1
    v_mul_u32_u24 v2, 1280, v2
    v_lshl_add_u32 v106, v1, 4, v2
    v_add_u32 v1, 1536, v9
    v_mul_u32_u24 v2, 1599, v1
    v_lshrrev_b32 v2, 17, v2
    v_mul_u32_u24 v3, 82, v2
    v_sub_u32 v1, v1, v3
    v_min_u32 v1, 79, v1
    v_mul_u32_u24 v2, 1280, v2
    v_lshl_add_u32 v107, v1, 4, v2
    v_add_u32 v1, 1792, v9
    v_mul_u32_u24 v2, 1599, v1
    v_lshrrev_b32 v2, 17, v2
    v_mul_u32_u24 v3, 82, v2
    v_sub_u32 v1, v1, v3
    v_min_u32 v1, 79, v1
    v_mul_u32_u24 v2, 1280, v2
    v_lshl_add_u32 v108, v1, 4, v2
    v_add_u32 v1, 2048, v9
    v_mul_u32_u24 v2, 1599, v1
    v_lshrrev_b32 v2, 17, v2
    v_mul_u32_u24 v3, 82, v2
    v_sub_u32 v1, v1, v3
    v_min_u32 v1, 79, v1
    v_mul_u32_u24 v2, 1280, v2
    v_lshl_add_u32 v109, v1, 4, v2
    v_add_u32 v1, 2304, v9
    v_mul_u32_u24 v2, 1599, v1
    v_lshrrev_b32 v2, 17, v2
    v_mul_u32_u24 v3, 82, v2
    v_sub_u32 v1, v1, v3
    v_min_u32 v1, 79, v1
    v_mul_u32_u24 v2, 1280, v2
    v_lshl_add_u32 v110, v1, 4, v2
    v_add_u32 v1, 2560, v0
    v_mul_u32_u24 v2, 1599, v1
    v_lshrrev_b32 v2, 17, v2
    v_mul_u32_u24 v3, 82, v2
    v_sub_u32 v1, v1, v3
    v_min_u32 v1, 79, v1
    v_mul_u32_u24 v2, 1280, v2
    v_lshl_add_u32 v111, v1, 4, v2
    s_waitcnt lgkmcnt(0)
    s_mul_i32 s6, s6, 0x9E3779B1
    s_add_u32 s6, s6, 0x7F4A7C15
    s_cmp_lt_u32 s58, 100
    s_cbranch_scc1 L_moe
    s_barrier
    s_endpgm
L_moe0:
    s_cmp_lt_u32 s3, 3
    s_cselect_b32 s54, 8, 6
    s_cselect_b32 s55, 0, 6
    s_mul_i32 s56, s3, s54
    s_add_u32 s56, s56, s55
    s_add_u32 s53, s63, s56
    s_mov_b32 s58, -1
    s_cmp_lt_u32 s63, s54
    s_cbranch_scc1 L_moe
    s_barrier
    s_cmp_lg_u32 s5, 0
    s_cbranch_scc1 L_fin
    s_lshl_b32 s59, s2, 7
    s_add_u32 s59, s59, 65536
    v_mov_b32 v32, s6
    v_mov_b32 v33, s7
    v_mov_b32 v34, s59
    s_mov_b64 exec, 0x1
    buffer_store_dwordx2 v[32:33], v34, s[36:39], 0 offen sc1
    s_mov_b64 exec, -1
    s_endpgm
.p2align 12
L_mbody:
    s_setprio 2
    s_waitcnt lgkmcnt(0)
    s_barrier
    ds_read_b128 v[16:19], v2 offset:448
    ds_read_b128 v[20:23], v2 offset:960
    ds_read_b128 v[24:27], v2 offset:1472
    ds_read_b128 v[28:31], v2 offset:1984
    ds_read_b128 v[32:35], v2 offset:384
    ds_read_b32 v15, v7
    s_waitcnt lgkmcnt(5)
    v_mfma_f32_16x16x32_bf16 v[96:99], a[0:3], v[16:19], 0
    v_mfma_f32_16x16x32_bf16 v[100:103], a[4:7], v[16:19], 0
    v_mfma_f32_16x16x32_bf16 v[104:107], a[8:11], v[16:19], 0
    ds_read_b128 v[36:39], v2 offset:896
    v_mfma_f32_16x16x32_bf16 v[108:111], a[12:15], v[16:19], 0
    s_waitcnt lgkmcnt(5)
    v_mfma_f32_16x16x32_bf16 v[100:103], a[0:3], v[20:23], v[100:103]
    v_mfma_f32_16x16x32_bf16 v[104:107], a[4:7], v[20:23], v[104:107]
    ds_read_b128 v[40:43], v2 offset:1408
    v_mfma_f32_16x16x32_bf16 v[108:111], a[8:11], v[20:23], v[108:111]
    s_waitcnt lgkmcnt(2)
    v_mfma_f32_16x16x32_bf16 v[104:107], a[0:3], v[24:27], v[104:107]
    ds_read_b128 v[44:47], v2 offset:1920
    v_mfma_f32_16x16x32_bf16 v[108:111], a[4:7], v[24:27], v[108:111]
    ds_read_b128 v[48:51], v2 offset:320
    v_mfma_f32_16x16x32_bf16 v[108:111], a[0:3], v[28:31], v[108:111]
    v_mfma_f32_16x16x32_bf16 v[96:99], a[16:19], v[32:35], v[96:99]
    v_mfma_f32_16x16x32_bf16 v[100:103], a[20:23], v[32:35], v[100:103]
    v_mfma_f32_16x16x32_bf16 v[104:107], a[24:27], v[32:35], v[104:107]
    ds_read_b128 v[52:55], v2 offset:832
    v_mfma_f32_16x16x32_bf16 v[108:111], a[28:31], v[32:35], v[108:111]
    s_waitcnt lgkmcnt(1)
    v_mfma_f32_16x16x32_bf16 v[100:103], a[16:19], v[36:39], v[100:103]
    v_mfma_f32_16x16x32_bf16 v[104:107], a[20:23], v[36:39], v[104:107]
    ds_read_b128 v[56:59], v2 offset:1344
    v_mfma_f32_16x16x32_bf16 v[108:111], a[24:27], v[36:39], v[108:111]
    v_mfma_f32_16x16x32_bf16 v[104:107], a[16:19], v[40:43], v[104:107]
    ds_read_b128 v[60:63], v2 offset:1856
    v_mfma_f32_16x16x32_bf16 v[108:111], a[20:23], v[40:43], v[108:111]
    ds_read_b128 v[64:67], v2 offset:256
    v_mfma_f32_16x16x32_bf16 v[108:111], a[16:19], v[44:47], v[108:111]
    v_mfma_f32_16x16x32_bf16 v[96:99], a[32:35], v[48:51], v[96:99]
    v_mfma_f32_16x16x32_bf16 v[100:103], a[36:39], v[48:51], v[100:103]
    v_mfma_f32_16x16x32_bf16 v[104:107], a[40:43], v[48:51], v[104:107]
    ds_read_b128 v[68:71], v2 offset:768
    v_mfma_f32_16x16x32_bf16 v[108:111], a[44:47], v[48:51], v[108:111]
    s_waitcnt lgkmcnt(1)
    v_mfma_f32_16x16x32_bf16 v[100:103], a[32:35], v[52:55], v[100:103]
    v_readfirstlane_b32 s54, v15
    s_nop 0
    s_cmp_lg_u32 s54, 4096
    v_mfma_f32_16x16x32_bf16 v[104:107], a[36:39], v[52:55], v[104:107]
    ds_read_b128 v[72:75], v2 offset:1280
    v_mfma_f32_16x16x32_bf16 v[108:111], a[40:43], v[52:55], v[108:111]
    v_mfma_f32_16x16x32_bf16 v[104:107], a[32:35], v[56:59], v[104:107]
    ds_read_b128 v[76:79], v2 offset:1792
    v_mfma_f32_16x16x32_bf16 v[108:111], a[36:39], v[56:59], v[108:111]
    ds_read_b128 v[80:83], v2 offset:192
    v_mfma_f32_16x16x32_bf16 v[108:111], a[32:35], v[60:63], v[108:111]
    ds_read_b128 a[64:67], v1 offset:256
    v_mfma_f32_16x16x32_bf16 v[96:99], a[48:51], v[64:67], v[96:99]
    ds_read_b128 a[68:71], v1 offset:768
    v_mfma_f32_16x16x32_bf16 v[100:103], a[52:55], v[64:67], v[100:103]
    ds_read_b128 a[72:75], v1 offset:1280
    v_mfma_f32_16x16x32_bf16 v[104:107], a[56:59], v[64:67], v[104:107]
    ds_read_b128 a[76:79], v1 offset:1792
    v_mfma_f32_16x16x32_bf16 v[108:111], a[60:63], v[64:67], v[108:111]
    ds_read_b128 v[84:87], v2 offset:704
    s_waitcnt lgkmcnt(5)
    v_mfma_f32_16x16x32_bf16 v[100:103], a[48:51], v[68:71], v[100:103]
    v_mfma_f32_16x16x32_bf16 v[104:107], a[52:55], v[68:71], v[104:107]
    ds_read_b128 v[88:91], v2 offset:1216
    v_mfma_f32_16x16x32_bf16 v[108:111], a[56:59], v[68:71], v[108:111]
    v_mfma_f32_16x16x32_bf16 v[104:107], a[48:51], v[72:75], v[104:107]
    ds_read_b128 v[92:95], v2 offset:1728
    v_mfma_f32_16x16x32_bf16 v[108:111], a[52:55], v[72:75], v[108:111]
    ds_read_b128 v[16:19], v2 offset:128
    v_mfma_f32_16x16x32_bf16 v[108:111], a[48:51], v[76:79], v[108:111]
    ds_read_b128 a[80:83], v1 offset:320
    s_waitcnt lgkmcnt(4)
    v_mfma_f32_16x16x32_bf16 v[96:99], a[64:67], v[80:83], v[96:99]
    ds_read_b128 a[84:87], v1 offset:832
    v_mfma_f32_16x16x32_bf16 v[100:103], a[68:71], v[80:83], v[100:103]
    ds_read_b128 a[88:91], v1 offset:1344
    v_mfma_f32_16x16x32_bf16 v[104:107], a[72:75], v[80:83], v[104:107]
    ds_read_b128 a[92:95], v1 offset:1856
    v_mfma_f32_16x16x32_bf16 v[108:111], a[76:79], v[80:83], v[108:111]
    ds_read_b128 v[20:23], v2 offset:640
    v_mfma_f32_16x16x32_bf16 v[100:103], a[64:67], v[84:87], v[100:103]
    v_mfma_f32_16x16x32_bf16 v[104:107], a[68:71], v[84:87], v[104:107]
    ds_read_b128 v[24:27], v2 offset:1152
    v_mfma_f32_16x16x32_bf16 v[108:111], a[72:75], v[84:87], v[108:111]
    s_waitcnt lgkmcnt(3)
    v_mfma_f32_16x16x32_bf16 v[104:107], a[64:67], v[88:91], v[104:107]
    ds_read_b128 v[28:31], v2 offset:1664
    v_mfma_f32_16x16x32_bf16 v[108:111], a[68:71], v[88:91], v[108:111]
    ds_read_b128 v[32:35], v2 offset:64
    v_mfma_f32_16x16x32_bf16 v[108:111], a[64:67], v[92:95], v[108:111]
    ds_read_b128 a[96:99], v1 offset:384
    v_mfma_f32_16x16x32_bf16 v[96:99], a[80:83], v[16:19], v[96:99]
    ds_read_b128 a[100:103], v1 offset:896
    v_mfma_f32_16x16x32_bf16 v[100:103], a[84:87], v[16:19], v[100:103]
    ds_read_b128 a[104:107], v1 offset:1408
    v_mfma_f32_16x16x32_bf16 v[104:107], a[88:91], v[16:19], v[104:107]
    ds_read_b128 a[108:111], v1 offset:1920
    s_waitcnt lgkmcnt(5)
    v_mfma_f32_16x16x32_bf16 v[108:111], a[92:95], v[16:19], v[108:111]
    ds_read_b128 v[36:39], v2 offset:576
    v_mfma_f32_16x16x32_bf16 v[100:103], a[80:83], v[20:23], v[100:103]
    v_mfma_f32_16x16x32_bf16 v[104:107], a[84:87], v[20:23], v[104:107]
    ds_read_b128 v[40:43], v2 offset:1088
    v_mfma_f32_16x16x32_bf16 v[108:111], a[88:91], v[20:23], v[108:111]
    v_mfma_f32_16x16x32_bf16 v[104:107], a[80:83], v[24:27], v[104:107]
    ds_read_b128 v[44:47], v2 offset:1600
    v_mfma_f32_16x16x32_bf16 v[108:111], a[84:87], v[24:27], v[108:111]
    ds_read_b128 v[48:51], v2 offset:0
    v_mfma_f32_16x16x32_bf16 v[108:111], a[80:83], v[28:31], v[108:111]
    ds_read_b128 a[112:115], v1 offset:448
    s_waitcnt lgkmcnt(4)
    v_mfma_f32_16x16x32_bf16 v[96:99], a[96:99], v[32:35], v[96:99]
    ds_read_b128 a[116:119], v1 offset:960
    v_mfma_f32_16x16x32_bf16 v[100:103], a[100:103], v[32:35], v[100:103]
    ds_read_b128 a[120:123], v1 offset:1472
    v_mfma_f32_16x16x32_bf16 v[104:107], a[104:107], v[32:35], v[104:107]
    ds_read_b128 a[124:127], v1 offset:1984
    v_mfma_f32_16x16x32_bf16 v[108:111], a[108:111], v[32:35], v[108:111]
    ds_read_b128 v[52:55], v2 offset:512
    v_mfma_f32_16x16x32_bf16 v[100:103], a[96:99], v[36:39], v[100:103]
    v_mfma_f32_16x16x32_bf16 v[104:107], a[100:103], v[36:39], v[104:107]
    ds_read_b128 v[56:59], v2 offset:1024
    v_mfma_f32_16x16x32_bf16 v[108:111], a[104:107], v[36:39], v[108:111]
    s_waitcnt lgkmcnt(3)
    v_mfma_f32_16x16x32_bf16 v[104:107], a[96:99], v[40:43], v[104:107]
    ds_read_b128 v[60:63], v2 offset:1536
    v_mfma_f32_16x16x32_bf16 v[108:111], a[100:103], v[40:43], v[108:111]
    ds_read_b128 v[64:67], v2 offset:448
    v_mfma_f32_16x16x32_bf16 v[108:111], a[96:99], v[44:47], v[108:111]
    ds_read_b128 v[68:71], v1 offset:2048
    v_mfma_f32_16x16x32_bf16 v[96:99], a[112:115], v[48:51], v[96:99]
    ds_read_b128 v[72:75], v1 offset:2560
    v_mfma_f32_16x16x32_bf16 v[100:103], a[116:119], v[48:51], v[100:103]
    ds_read_b128 v[76:79], v1 offset:3072
    v_mfma_f32_16x16x32_bf16 v[104:107], a[120:123], v[48:51], v[104:107]
    ds_read_b128 v[80:83], v1 offset:3584
    s_waitcnt lgkmcnt(5)
    v_mfma_f32_16x16x32_bf16 v[108:111], a[124:127], v[48:51], v[108:111]
    ds_read_b128 v[84:87], v2 offset:960
    v_mfma_f32_16x16x32_bf16 v[100:103], a[112:115], v[52:55], v[100:103]
    v_mfma_f32_16x16x32_bf16 v[104:107], a[116:119], v[52:55], v[104:107]
    v_mfma_f32_16x16x32_bf16 v[108:111], a[120:123], v[52:55], v[108:111]
    ds_read_b128 v[88:91], v2 offset:1472
    v_mfma_f32_16x16x32_bf16 v[104:107], a[112:115], v[56:59], v[104:107]
    v_mfma_f32_16x16x32_bf16 v[108:111], a[116:119], v[56:59], v[108:111]
    v_mfma_f32_16x16x32_bf16 v[108:111], a[112:115], v[60:63], v[108:111]
    s_waitcnt lgkmcnt(1)
    v_mfma_f32_16x16x32_bf16 v[112:115], v[68:71], v[64:67], 0
    ds_read_b128 v[92:95], v2 offset:1984
    v_mfma_f32_16x16x32_bf16 v[116:119], v[72:75], v[64:67], 0
    v_mfma_f32_16x16x32_bf16 v[120:123], v[76:79], v[64:67], 0
    v_mfma_f32_16x16x32_bf16 v[124:127], v[80:83], v[64:67], 0
    v_mfma_f32_16x16x32_bf16 v[112:115], a[12:15], v[84:87], v[112:115]
    v_cvt_pk_bf16_f32 v96, v96, v97
    ds_read_b128 v[16:19], v2 offset:2496
    v_mfma_f32_16x16x32_bf16 v[116:119], v[68:71], v[84:87], v[116:119]
    v_cvt_pk_bf16_f32 v97, v98, v99
    v_mfma_f32_16x16x32_bf16 v[120:123], v[72:75], v[84:87], v[120:123]
    s_cbranch_scc1 L_ys0
    buffer_store_dwordx2 v[96:97], v4, s[36:39], s60 offen offset:0
L_yr0:
    v_mfma_f32_16x16x32_bf16 v[124:127], v[76:79], v[84:87], v[124:127]
    v_cvt_pk_bf16_f32 v100, v100, v101
    s_waitcnt lgkmcnt(1)
    v_mfma_f32_16x16x32_bf16 v[112:115], a[8:11], v[88:91], v[112:115]
    v_cvt_pk_bf16_f32 v101, v102, v103
    ds_read_b128 v[20:23], v2 offset:384
    v_mfma_f32_16x16x32_bf16 v[116:119], a[12:15], v[88:91], v[116:119]
    s_cbranch_scc1 L_ys1
    buffer_store_dwordx2 v[100:101], v4, s[36:39], s60 offen offset:512
L_yr1:
    ds_read_b128 v[24:27], v1 offset:2112
    v_mfma_f32_16x16x32_bf16 v[120:123], v[68:71], v[88:91], v[120:123]
    v_cvt_pk_bf16_f32 v104, v104, v105
    ds_read_b128 v[28:31], v1 offset:2624
    v_mfma_f32_16x16x32_bf16 v[124:127], v[72:75], v[88:91], v[124:127]
    v_cvt_pk_bf16_f32 v105, v106, v107
    ds_read_b128 v[32:35], v1 offset:3136
    v_mfma_f32_16x16x32_bf16 v[112:115], a[4:7], v[92:95], v[112:115]
    s_cbranch_scc1 L_ys2
    buffer_store_dwordx2 v[104:105], v4, s[36:39], s60 offen offset:1024
L_yr2:
    ds_read_b128 v[36:39], v1 offset:3648
    v_mfma_f32_16x16x32_bf16 v[116:119], a[8:11], v[92:95], v[116:119]
    v_cvt_pk_bf16_f32 v108, v108, v109
    ds_read_b128 v[40:43], v2 offset:896
    v_mfma_f32_16x16x32_bf16 v[120:123], a[12:15], v[92:95], v[120:123]
    v_cvt_pk_bf16_f32 v109, v110, v111
    v_mfma_f32_16x16x32_bf16 v[124:127], v[68:71], v[92:95], v[124:127]
    s_cbranch_scc1 L_ys3
    buffer_store_dwordx2 v[108:109], v4, s[36:39], s60 offen offset:1536
L_yr3:
    s_waitcnt lgkmcnt(3)
    v_mfma_f32_16x16x32_bf16 v[112:115], a[0:3], v[16:19], v[112:115]
    ds_read_b128 v[44:47], v2 offset:1408
    v_mfma_f32_16x16x32_bf16 v[116:119], a[4:7], v[16:19], v[116:119]
    v_mfma_f32_16x16x32_bf16 v[120:123], a[8:11], v[16:19], v[120:123]
    v_mfma_f32_16x16x32_bf16 v[124:127], a[12:15], v[16:19], v[124:127]
    v_mfma_f32_16x16x32_bf16 v[112:115], v[24:27], v[20:23], v[112:115]
    ds_read_b128 v[48:51], v2 offset:1920
    v_mfma_f32_16x16x32_bf16 v[116:119], v[28:31], v[20:23], v[116:119]
    s_waitcnt lgkmcnt(1)
    v_mfma_f32_16x16x32_bf16 v[120:123], v[32:35], v[20:23], v[120:123]
    v_mfma_f32_16x16x32_bf16 v[124:127], v[36:39], v[20:23], v[124:127]
    v_mfma_f32_16x16x32_bf16 v[112:115], a[28:31], v[40:43], v[112:115]
    ds_read_b128 v[52:55], v2 offset:2432
    v_mfma_f32_16x16x32_bf16 v[116:119], v[24:27], v[40:43], v[116:119]
    v_mfma_f32_16x16x32_bf16 v[120:123], v[28:31], v[40:43], v[120:123]
    v_mfma_f32_16x16x32_bf16 v[124:127], v[32:35], v[40:43], v[124:127]
    v_mfma_f32_16x16x32_bf16 v[112:115], a[24:27], v[44:47], v[112:115]
    ds_read_b128 v[56:59], v2 offset:320
    v_mfma_f32_16x16x32_bf16 v[116:119], a[28:31], v[44:47], v[116:119]
    ds_read_b128 v[60:63], v1 offset:2176
    v_mfma_f32_16x16x32_bf16 v[120:123], v[24:27], v[44:47], v[120:123]
    ds_read_b128 v[64:67], v1 offset:2688
    v_mfma_f32_16x16x32_bf16 v[124:127], v[28:31], v[44:47], v[124:127]
    ds_read_b128 v[80:83], v1 offset:3200
    s_waitcnt lgkmcnt(4)
    v_mfma_f32_16x16x32_bf16 v[112:115], a[20:23], v[48:51], v[112:115]
    ds_read_b128 v[76:79], v1 offset:3712
    v_mfma_f32_16x16x32_bf16 v[116:119], a[24:27], v[48:51], v[116:119]
    ds_read_b128 v[84:87], v2 offset:832
    v_mfma_f32_16x16x32_bf16 v[120:123], a[28:31], v[48:51], v[120:123]
    v_mfma_f32_16x16x32_bf16 v[124:127], v[24:27], v[48:51], v[124:127]
    v_mfma_f32_16x16x32_bf16 v[112:115], a[16:19], v[52:55], v[112:115]
    ds_read_b128 v[72:75], v2 offset:1344
    v_mfma_f32_16x16x32_bf16 v[116:119], a[20:23], v[52:55], v[116:119]
    v_mfma_f32_16x16x32_bf16 v[120:123], a[24:27], v[52:55], v[120:123]
    v_mfma_f32_16x16x32_bf16 v[124:127], a[28:31], v[52:55], v[124:127]
    s_waitcnt lgkmcnt(1)
    v_mfma_f32_16x16x32_bf16 v[112:115], v[60:63], v[56:59], v[112:115]
    ds_read_b128 v[88:91], v2 offset:1856
    v_mfma_f32_16x16x32_bf16 v[116:119], v[64:67], v[56:59], v[116:119]
    v_mfma_f32_16x16x32_bf16 v[120:123], v[80:83], v[56:59], v[120:123]
    v_mfma_f32_16x16x32_bf16 v[124:127], v[76:79], v[56:59], v[124:127]
    v_mfma_f32_16x16x32_bf16 v[112:115], a[44:47], v[84:87], v[112:115]
    ds_read_b128 v[68:71], v2 offset:2368
    v_mfma_f32_16x16x32_bf16 v[116:119], v[60:63], v[84:87], v[116:119]
    v_mfma_f32_16x16x32_bf16 v[120:123], v[64:67], v[84:87], v[120:123]
    v_mfma_f32_16x16x32_bf16 v[124:127], v[80:83], v[84:87], v[124:127]
    s_waitcnt lgkmcnt(1)
    v_mfma_f32_16x16x32_bf16 v[112:115], a[40:43], v[72:75], v[112:115]
    ds_read_b128 v[92:95], v2 offset:256
    v_mfma_f32_16x16x32_bf16 v[116:119], a[44:47], v[72:75], v[116:119]
    ds_read_b128 v[16:19], v1 offset:2240
    v_mfma_f32_16x16x32_bf16 v[120:123], v[60:63], v[72:75], v[120:123]
    ds_read_b128 v[20:23], v1 offset:2752
    v_mfma_f32_16x16x32_bf16 v[124:127], v[64:67], v[72:75], v[124:127]
    ds_read_b128 v[36:39], v1 offset:3264
    v_mfma_f32_16x16x32_bf16 v[112:115], a[36:39], v[88:91], v[112:115]
    ds_read_b128 v[32:35], v1 offset:3776
    v_mfma_f32_16x16x32_bf16 v[116:119], a[40:43], v[88:91], v[116:119]
    ds_read_b128 v[40:43], v2 offset:768
    v_mfma_f32_16x16x32_bf16 v[120:123], a[44:47], v[88:91], v[120:123]
    v_mfma_f32_16x16x32_bf16 v[124:127], v[60:63], v[88:91], v[124:127]
    s_waitcnt vmcnt(0)
    s_mov_b64 exec, 1
    s_cbranch_scc1 L_ys4
    buffer_store_dword v6, v5, s[36:39], s61 offen offset:512
L_yr4:
    s_mov_b64 exec, -1
    s_waitcnt lgkmcnt(3)
    v_mfma_f32_16x16x32_bf16 v[112:115], a[32:35], v[68:71], v[112:115]
    ds_read_b128 v[28:31], v2 offset:1280
    v_mfma_f32_16x16x32_bf16 v[116:119], a[36:39], v[68:71], v[116:119]
    v_mfma_f32_16x16x32_bf16 v[120:123], a[40:43], v[68:71], v[120:123]
    v_mfma_f32_16x16x32_bf16 v[124:127], a[44:47], v[68:71], v[124:127]
    v_mfma_f32_16x16x32_bf16 v[112:115], v[16:19], v[92:95], v[112:115]
    ds_read_b128 v[44:47], v2 offset:1792
    v_mfma_f32_16x16x32_bf16 v[116:119], v[20:23], v[92:95], v[116:119]
    s_waitcnt lgkmcnt(1)
    v_mfma_f32_16x16x32_bf16 v[120:123], v[36:39], v[92:95], v[120:123]
    v_mfma_f32_16x16x32_bf16 v[124:127], v[32:35], v[92:95], v[124:127]
    v_mfma_f32_16x16x32_bf16 v[112:115], a[60:63], v[40:43], v[112:115]
    ds_read_b128 v[24:27], v2 offset:2304
    v_mfma_f32_16x16x32_bf16 v[116:119], v[16:19], v[40:43], v[116:119]
    v_mfma_f32_16x16x32_bf16 v[120:123], v[20:23], v[40:43], v[120:123]
    v_mfma_f32_16x16x32_bf16 v[124:127], v[36:39], v[40:43], v[124:127]
    v_mfma_f32_16x16x32_bf16 v[112:115], a[56:59], v[28:31], v[112:115]
    ds_read_b128 v[48:51], v2 offset:192
    v_mfma_f32_16x16x32_bf16 v[116:119], a[60:63], v[28:31], v[116:119]
    ds_read_b128 v[52:55], v1 offset:2304
    v_mfma_f32_16x16x32_bf16 v[120:123], v[16:19], v[28:31], v[120:123]
    ds_read_b128 v[56:59], v1 offset:2816
    v_mfma_f32_16x16x32_bf16 v[124:127], v[20:23], v[28:31], v[124:127]
    ds_read_b128 v[76:79], v1 offset:3328
    s_waitcnt lgkmcnt(4)
    v_mfma_f32_16x16x32_bf16 v[112:115], a[52:55], v[44:47], v[112:115]
    ds_read_b128 v[80:83], v1 offset:3840
    v_mfma_f32_16x16x32_bf16 v[116:119], a[56:59], v[44:47], v[116:119]
    ds_read_b128 v[84:87], v2 offset:704
    v_mfma_f32_16x16x32_bf16 v[120:123], a[60:63], v[44:47], v[120:123]
    v_mfma_f32_16x16x32_bf16 v[124:127], v[16:19], v[44:47], v[124:127]
    v_mfma_f32_16x16x32_bf16 v[112:115], a[48:51], v[24:27], v[112:115]
    ds_read_b128 v[64:67], v2 offset:1216
    v_mfma_f32_16x16x32_bf16 v[116:119], a[52:55], v[24:27], v[116:119]
    v_mfma_f32_16x16x32_bf16 v[120:123], a[56:59], v[24:27], v[120:123]
    v_mfma_f32_16x16x32_bf16 v[124:127], a[60:63], v[24:27], v[124:127]
    s_waitcnt lgkmcnt(1)
    v_mfma_f32_16x16x32_bf16 v[112:115], v[52:55], v[48:51], v[112:115]
    ds_read_b128 v[72:75], v2 offset:1728
    v_mfma_f32_16x16x32_bf16 v[116:119], v[56:59], v[48:51], v[116:119]
    v_mfma_f32_16x16x32_bf16 v[120:123], v[76:79], v[48:51], v[120:123]
    v_mfma_f32_16x16x32_bf16 v[124:127], v[80:83], v[48:51], v[124:127]
    v_mfma_f32_16x16x32_bf16 v[112:115], a[76:79], v[84:87], v[112:115]
    ds_read_b128 v[60:63], v2 offset:2240
    v_mfma_f32_16x16x32_bf16 v[116:119], v[52:55], v[84:87], v[116:119]
    v_mfma_f32_16x16x32_bf16 v[120:123], v[56:59], v[84:87], v[120:123]
    v_mfma_f32_16x16x32_bf16 v[124:127], v[76:79], v[84:87], v[124:127]
    s_waitcnt lgkmcnt(1)
    v_mfma_f32_16x16x32_bf16 v[112:115], a[72:75], v[64:67], v[112:115]
    ds_read_b128 v[88:91], v2 offset:128
    v_mfma_f32_16x16x32_bf16 v[116:119], a[76:79], v[64:67], v[116:119]
    ds_read_b128 v[68:71], v1 offset:2368
    v_mfma_f32_16x16x32_bf16 v[120:123], v[52:55], v[64:67], v[120:123]
    ds_read_b128 v[92:95], v1 offset:2880
    v_mfma_f32_16x16x32_bf16 v[124:127], v[56:59], v[64:67], v[124:127]
    ds_read_b128 v[32:35], v1 offset:3392
    v_mfma_f32_16x16x32_bf16 v[112:115], a[68:71], v[72:75], v[112:115]
    ds_read_b128 v[36:39], v1 offset:3904
    v_mfma_f32_16x16x32_bf16 v[116:119], a[72:75], v[72:75], v[116:119]
    ds_read_b128 v[40:43], v2 offset:640
    v_mfma_f32_16x16x32_bf16 v[120:123], a[76:79], v[72:75], v[120:123]
    v_mfma_f32_16x16x32_bf16 v[124:127], v[52:55], v[72:75], v[124:127]
    s_waitcnt lgkmcnt(3)
    v_mfma_f32_16x16x32_bf16 v[112:115], a[64:67], v[60:63], v[112:115]
    ds_read_b128 v[20:23], v2 offset:1152
    v_mfma_f32_16x16x32_bf16 v[116:119], a[68:71], v[60:63], v[116:119]
    v_mfma_f32_16x16x32_bf16 v[120:123], a[72:75], v[60:63], v[120:123]
    v_mfma_f32_16x16x32_bf16 v[124:127], a[76:79], v[60:63], v[124:127]
    v_mfma_f32_16x16x32_bf16 v[112:115], v[68:71], v[88:91], v[112:115]
    ds_read_b128 v[28:31], v2 offset:1664
    v_mfma_f32_16x16x32_bf16 v[116:119], v[92:95], v[88:91], v[116:119]
    s_waitcnt lgkmcnt(1)
    v_mfma_f32_16x16x32_bf16 v[120:123], v[32:35], v[88:91], v[120:123]
    v_mfma_f32_16x16x32_bf16 v[124:127], v[36:39], v[88:91], v[124:127]
    v_mfma_f32_16x16x32_bf16 v[112:115], a[92:95], v[40:43], v[112:115]
    ds_read_b128 v[16:19], v2 offset:2176
    v_mfma_f32_16x16x32_bf16 v[116:119], v[68:71], v[40:43], v[116:119]
    v_mfma_f32_16x16x32_bf16 v[120:123], v[92:95], v[40:43], v[120:123]
    v_mfma_f32_16x16x32_bf16 v[124:127], v[32:35], v[40:43], v[124:127]
    v_mfma_f32_16x16x32_bf16 v[112:115], a[88:91], v[20:23], v[112:115]
    ds_read_b128 v[44:47], v2 offset:64
    v_mfma_f32_16x16x32_bf16 v[116:119], a[92:95], v[20:23], v[116:119]
    ds_read_b128 v[24:27], v1 offset:2432
    v_mfma_f32_16x16x32_bf16 v[120:123], v[68:71], v[20:23], v[120:123]
    ds_read_b128 v[48:51], v1 offset:2944
    v_mfma_f32_16x16x32_bf16 v[124:127], v[92:95], v[20:23], v[124:127]
    ds_read_b128 v[80:83], v1 offset:3456
    s_waitcnt lgkmcnt(4)
    v_mfma_f32_16x16x32_bf16 v[112:115], a[84:87], v[28:31], v[112:115]
    ds_read_b128 v[76:79], v1 offset:3968
    v_mfma_f32_16x16x32_bf16 v[116:119], a[88:91], v[28:31], v[116:119]
    ds_read_b128 v[84:87], v2 offset:576
    v_mfma_f32_16x16x32_bf16 v[120:123], a[92:95], v[28:31], v[120:123]
    v_mfma_f32_16x16x32_bf16 v[124:127], v[68:71], v[28:31], v[124:127]
    v_mfma_f32_16x16x32_bf16 v[112:115], a[80:83], v[16:19], v[112:115]
    ds_read_b128 v[56:59], v2 offset:1088
    v_mfma_f32_16x16x32_bf16 v[116:119], a[84:87], v[16:19], v[116:119]
    v_mfma_f32_16x16x32_bf16 v[120:123], a[88:91], v[16:19], v[120:123]
    v_mfma_f32_16x16x32_bf16 v[124:127], a[92:95], v[16:19], v[124:127]
    s_waitcnt lgkmcnt(1)
    v_mfma_f32_16x16x32_bf16 v[112:115], v[24:27], v[44:47], v[112:115]
    ds_read_b128 v[64:67], v2 offset:1600
    v_mfma_f32_16x16x32_bf16 v[116:119], v[48:51], v[44:47], v[116:119]
    v_mfma_f32_16x16x32_bf16 v[120:123], v[80:83], v[44:47], v[120:123]
    v_mfma_f32_16x16x32_bf16 v[124:127], v[76:79], v[44:47], v[124:127]
    v_mfma_f32_16x16x32_bf16 v[112:115], a[108:111], v[84:87], v[112:115]
    ds_read_b128 v[52:55], v2 offset:2112
    v_mfma_f32_16x16x32_bf16 v[116:119], v[24:27], v[84:87], v[116:119]
    v_mfma_f32_16x16x32_bf16 v[120:123], v[48:51], v[84:87], v[120:123]
    v_mfma_f32_16x16x32_bf16 v[124:127], v[80:83], v[84:87], v[124:127]
    s_waitcnt lgkmcnt(1)
    v_mfma_f32_16x16x32_bf16 v[112:115], a[104:107], v[56:59], v[112:115]
    ds_read_b128 v[72:75], v2 offset:0
    v_mfma_f32_16x16x32_bf16 v[116:119], a[108:111], v[56:59], v[116:119]
    ds_read_b128 v[60:63], v1 offset:2496
    v_mfma_f32_16x16x32_bf16 v[120:123], v[24:27], v[56:59], v[120:123]
    ds_read_b128 v[88:91], v1 offset:3008
    v_mfma_f32_16x16x32_bf16 v[124:127], v[48:51], v[56:59], v[124:127]
    ds_read_b128 v[36:39], v1 offset:3520
    v_mfma_f32_16x16x32_bf16 v[112:115], a[100:103], v[64:67], v[112:115]
    ds_read_b128 v[32:35], v1 offset:4032
    v_mfma_f32_16x16x32_bf16 v[116:119], a[104:107], v[64:67], v[116:119]
    ds_read_b128 v[40:43], v2 offset:512
    v_mfma_f32_16x16x32_bf16 v[120:123], a[108:111], v[64:67], v[120:123]
    v_mfma_f32_16x16x32_bf16 v[124:127], v[24:27], v[64:67], v[124:127]
    s_waitcnt lgkmcnt(3)
    v_mfma_f32_16x16x32_bf16 v[112:115], a[96:99], v[52:55], v[112:115]
    ds_read_b128 v[92:95], v2 offset:1024
    v_mfma_f32_16x16x32_bf16 v[116:119], a[100:103], v[52:55], v[116:119]
    v_mfma_f32_16x16x32_bf16 v[120:123], a[104:107], v[52:55], v[120:123]
    v_mfma_f32_16x16x32_bf16 v[124:127], a[108:111], v[52:55], v[124:127]
    v_mfma_f32_16x16x32_bf16 v[112:115], v[60:63], v[72:75], v[112:115]
    v_mfma_f32_16x16x32_bf16 v[116:119], v[88:91], v[72:75], v[116:119]
    s_waitcnt lgkmcnt(0)
    v_mfma_f32_16x16x32_bf16 v[120:123], v[36:39], v[72:75], v[120:123]
    ds_read_b32 v14, v12 offset:0
    ds_read_b128 v[68:71], v2 offset:1536
    v_mfma_f32_16x16x32_bf16 v[124:127], v[32:35], v[72:75], v[124:127]
    v_mfma_f32_16x16x32_bf16 v[112:115], a[124:127], v[40:43], v[112:115]
    ds_read_b128 v[28:31], v2 offset:2048
    v_mfma_f32_16x16x32_bf16 v[116:119], v[60:63], v[40:43], v[116:119]
    v_mfma_f32_16x16x32_bf16 v[120:123], v[88:91], v[40:43], v[120:123]
    v_mfma_f32_16x16x32_bf16 v[124:127], v[36:39], v[40:43], v[124:127]
    v_mfma_f32_16x16x32_bf16 v[112:115], a[120:123], v[92:95], v[112:115]
    v_mfma_f32_16x16x32_bf16 v[116:119], a[124:127], v[92:95], v[116:119]
    s_waitcnt lgkmcnt(0)
    v_mfma_f32_16x16x32_bf16 v[120:123], v[60:63], v[92:95], v[120:123]
    v_cmp_eq_u32 vcc, 0, v14
    s_nop 0
    s_cbranch_vccnz L_s2wait
L_s2go:
    ds_read_b128 v[16:19], v2 offset:3008
    v_mfma_f32_16x16x32_bf16 v[124:127], v[88:91], v[92:95], v[124:127]
    ds_read_b128 v[44:47], v2 offset:3520
    v_mfma_f32_16x16x32_bf16 v[112:115], a[116:119], v[68:71], v[112:115]
    v_mfma_f32_16x16x32_bf16 v[116:119], a[120:123], v[68:71], v[116:119]
    ds_read_b128 v[76:79], v2 offset:2944
    v_mfma_f32_16x16x32_bf16 v[120:123], a[124:127], v[68:71], v[120:123]
    v_mfma_f32_16x16x32_bf16 v[124:127], v[60:63], v[68:71], v[124:127]
    v_mfma_f32_16x16x32_bf16 v[112:115], a[112:115], v[28:31], v[112:115]
    ds_read_b128 v[80:83], v2 offset:3456
    v_mfma_f32_16x16x32_bf16 v[116:119], a[116:119], v[28:31], v[116:119]
    v_mfma_f32_16x16x32_bf16 v[120:123], a[120:123], v[28:31], v[120:123]
    ds_read_b128 v[84:87], v2 offset:2880
    v_mfma_f32_16x16x32_bf16 v[124:127], a[124:127], v[28:31], v[124:127]
    s_waitcnt lgkmcnt(2)
    v_mfma_f32_16x16x32_bf16 v[116:119], a[0:3], v[16:19], v[116:119]
    v_mfma_f32_16x16x32_bf16 v[120:123], a[4:7], v[16:19], v[120:123]
    ds_read_b128 v[48:51], v2 offset:3392
    v_mfma_f32_16x16x32_bf16 v[124:127], a[8:11], v[16:19], v[124:127]
    v_mfma_f32_16x16x32_bf16 v[120:123], a[0:3], v[44:47], v[120:123]
    ds_read_b128 v[56:59], v2 offset:2816
    v_mfma_f32_16x16x32_bf16 v[124:127], a[4:7], v[44:47], v[124:127]
    v_mfma_f32_16x16x32_bf16 v[116:119], a[16:19], v[76:79], v[116:119]
    v_mfma_f32_16x16x32_bf16 v[120:123], a[20:23], v[76:79], v[120:123]
    ds_read_b128 v[24:27], v2 offset:3328
    v_mfma_f32_16x16x32_bf16 v[124:127], a[24:27], v[76:79], v[124:127]
    s_waitcnt lgkmcnt(2)
    v_mfma_f32_16x16x32_bf16 v[120:123], a[16:19], v[80:83], v[120:123]
    ds_read_b128 v[64:67], v2 offset:2752
    v_mfma_f32_16x16x32_bf16 v[124:127], a[20:23], v[80:83], v[124:127]
    v_mfma_f32_16x16x32_bf16 v[116:119], a[32:35], v[84:87], v[116:119]
    v_mfma_f32_16x16x32_bf16 v[120:123], a[36:39], v[84:87], v[120:123]
    ds_read_b128 v[52:55], v2 offset:3264
    v_mfma_f32_16x16x32_bf16 v[124:127], a[40:43], v[84:87], v[124:127]
    v_mfma_f32_16x16x32_bf16 v[120:123], a[32:35], v[48:51], v[120:123]
    ds_read_b128 v[72:75], v2 offset:2688
    v_mfma_f32_16x16x32_bf16 v[124:127], a[36:39], v[48:51], v[124:127]
    s_waitcnt lgkmcnt(2)
    v_mfma_f32_16x16x32_bf16 v[116:119], a[48:51], v[56:59], v[116:119]
    v_mfma_f32_16x16x32_bf16 v[120:123], a[52:55], v[56:59], v[120:123]
    ds_read_b128 v[32:35], v2 offset:3200
    v_mfma_f32_16x16x32_bf16 v[124:127], a[56:59], v[56:59], v[124:127]
    v_mfma_f32_16x16x32_bf16 v[120:123], a[48:51], v[24:27], v[120:123]
    ds_read_b128 v[36:39], v2 offset:2624
    v_mfma_f32_16x16x32_bf16 v[124:127], a[52:55], v[24:27], v[124:127]
    v_mfma_f32_16x16x32_bf16 v[116:119], a[64:67], v[64:67], v[116:119]
    v_mfma_f32_16x16x32_bf16 v[120:123], a[68:71], v[64:67], v[120:123]
    ds_read_b128 v[40:43], v2 offset:3136
    v_mfma_f32_16x16x32_bf16 v[124:127], a[72:75], v[64:67], v[124:127]
    s_waitcnt lgkmcnt(2)
    v_mfma_f32_16x16x32_bf16 v[120:123], a[64:67], v[52:55], v[120:123]
    ds_read_b128 v[20:23], v2 offset:2560
    v_mfma_f32_16x16x32_bf16 v[124:127], a[68:71], v[52:55], v[124:127]
    v_mfma_f32_16x16x32_bf16 v[116:119], a[80:83], v[72:75], v[116:119]
    v_mfma_f32_16x16x32_bf16 v[120:123], a[84:87], v[72:75], v[120:123]
    v_mfma_f32_16x16x32_bf16 v[124:127], a[88:91], v[72:75], v[124:127]
    ds_read_b32 v14, v12 offset:16
    ds_read_b128 v[92:95], v2 offset:3072
    v_mfma_f32_16x16x32_bf16 v[120:123], a[80:83], v[32:35], v[120:123]
    ds_read_b128 v[60:63], v2 offset:4032
    v_mfma_f32_16x16x32_bf16 v[124:127], a[84:87], v[32:35], v[124:127]
    ds_read_b128 v[68:71], v2 offset:3968
    s_waitcnt lgkmcnt(4)
    v_mfma_f32_16x16x32_bf16 v[116:119], a[96:99], v[36:39], v[116:119]
    ds_read_b128 v[28:31], v2 offset:3904
    v_mfma_f32_16x16x32_bf16 v[120:123], a[100:103], v[36:39], v[120:123]
    ds_read_b128 v[16:19], v2 offset:3840
    v_mfma_f32_16x16x32_bf16 v[124:127], a[104:107], v[36:39], v[124:127]
    ds_read_b128 v[44:47], v2 offset:3776
    v_mfma_f32_16x16x32_bf16 v[120:123], a[96:99], v[40:43], v[120:123]
    ds_read_b128 v[76:79], v2 offset:3712
    v_mfma_f32_16x16x32_bf16 v[124:127], a[100:103], v[40:43], v[124:127]
    ds_read_b128 v[80:83], v2 offset:3648
    s_waitcnt lgkmcnt(5)
    v_mfma_f32_16x16x32_bf16 v[116:119], a[112:115], v[20:23], v[116:119]
    v_cmp_eq_u32 vcc, 0, v14
    s_nop 0
    s_cbranch_vccnz L_s3wait
L_s3go:
    ds_read_b128 v[84:87], v2 offset:3584
    v_mfma_f32_16x16x32_bf16 v[120:123], a[116:119], v[20:23], v[120:123]
    v_cvt_pk_bf16_f32 v112, v112, v113
    v_mfma_f32_16x16x32_bf16 v[124:127], a[120:123], v[20:23], v[124:127]
    v_cvt_pk_bf16_f32 v113, v114, v115
    v_mfma_f32_16x16x32_bf16 v[120:123], a[112:115], v[92:95], v[120:123]
    s_cbranch_scc1 L_ys5
    buffer_store_dwordx2 v[112:113], v4, s[36:39], s60 offen offset:2048
L_yr5:
    v_mfma_f32_16x16x32_bf16 v[124:127], a[116:119], v[92:95], v[124:127]
    v_mfma_f32_16x16x32_bf16 v[124:127], a[0:3], v[60:63], v[124:127]
    v_mfma_f32_16x16x32_bf16 v[124:127], a[16:19], v[68:71], v[124:127]
    s_waitcnt lgkmcnt(0)
    v_mfma_f32_16x16x32_bf16 v[124:127], a[32:35], v[28:31], v[124:127]
    v_cvt_pk_bf16_f32 v116, v116, v117
    v_mfma_f32_16x16x32_bf16 v[124:127], a[48:51], v[16:19], v[124:127]
    v_cvt_pk_bf16_f32 v117, v118, v119
    v_mfma_f32_16x16x32_bf16 v[124:127], a[64:67], v[44:47], v[124:127]
    s_cbranch_scc1 L_ys6
    buffer_store_dwordx2 v[116:117], v4, s[36:39], s60 offen offset:2560
L_yr6:
    v_mfma_f32_16x16x32_bf16 v[124:127], a[80:83], v[76:79], v[124:127]
    v_mfma_f32_16x16x32_bf16 v[124:127], a[96:99], v[80:83], v[124:127]
    v_mfma_f32_16x16x32_bf16 v[124:127], a[112:115], v[84:87], v[124:127]
    v_cvt_pk_bf16_f32 v120, v120, v121
    v_cvt_pk_bf16_f32 v121, v122, v123
    s_cbranch_scc1 L_ys7
    buffer_store_dwordx2 v[120:121], v4, s[36:39], s60 offen offset:3072
L_yr7:
    s_nop 3
    v_cvt_pk_bf16_f32 v124, v124, v125
    v_cvt_pk_bf16_f32 v125, v126, v127
    s_cbranch_scc1 L_ys8
    buffer_store_dwordx2 v[124:125], v4, s[36:39], s60 offen offset:3584
L_yr8:
    s_barrier
    s_waitcnt vmcnt(0)
    s_mov_b64 exec, 1
    s_cbranch_scc1 L_ys9
    buffer_store_dword v6, v5, s[36:39], s61 offen offset:1024
L_yr9:
    s_mov_b64 exec, -1
    s_endpgm
.p2align 12
L_moe:
    s_mov_b32 s57, 0x3f803f80
    v_mov_b32 v16, s57
    v_mov_b32 v17, s57
    v_mov_b32 v18, s57
    v_mov_b32 v19, s57
    s_mov_b32 s57, 128256
    v_lshl_add_u32 v2, v0, 4, s57
    ds_write_b128 v2, v[16:19]
    ds_write_b128 v2, v[16:19] offset:256
    v_bfe_u32 v1, v0, 3, 1
    v_lshrrev_b32 v2, 4, v0
    v_bfe_u32 v10, v0, 2, 2
    v_and_b32 v11, 3, v0
    v_lshl_add_u32 v14, v2, 3, v10
    v_mul_u32_u24 v12, 1312, v14
    s_mul_i32 s57, s5, 160
    s_add_u32 s57, s57, 81984
    v_lshl_add_u32 v13, v11, 3, s57
    v_add_u32 v12, v12, v13
    s_and_b32 s60, s5, 1
    s_lshr_b32 s61, s5, 1
    v_lshlrev_b32 v14, 6, v14
    v_lshrrev_b32 v15, 1, v11
    v_mul_u32_u24 v15, 40976, v15
    v_add_u32 v14, v14, v15
    v_and_b32 v15, 1, v11
    v_lshl_add_u32 v14, v15, 3, v14
    v_and_b32 v15, 1, v2
    v_lshlrev_b32 v15, 1, v15
    v_xor_b32 v15, s61, v15
    v_lshl_add_u32 v14, v15, 4, v14
    s_bitcmp1_b32 s53, 0
    s_cselect_b32 s99, 2, 0
    s_add_u32 s59, s99, s60
    s_mul_i32 s57, s59, 10240
    v_add_u32 v92, s57, v14
    s_xor_b32 s57, s59, 2
    s_mul_i32 s57, s57, 10240
    v_add_u32 v14, s57, v14
    v_and_b32 v10, 7, v0
    v_lshl_add_u32 v11, v2, 3, v10
    v_lshlrev_b32 v11, 2, v11
    v_add_u32 v37, 124480, v11
    v_lshl_add_u32 v36, v1, 8, v11
    v_add_u32 v36, 123968, v36
    v_and_b32 v18, 1, v10
    v_mov_b32 v19, 0xffff
    v_mov_b32 v20, s52
    v_cmp_eq_u32 vcc, 1, v18
    s_nop 1
    v_cndmask_b32 v18, v19, v20, vcc
    v_lshrrev_b32 v13, 1, v10
    v_cmp_eq_u32 vcc, 0, v13
    s_nop 1
    v_cndmask_b32 v80, 0, v18, vcc
    v_cmp_eq_u32 vcc, 1, v13
    s_nop 1
    v_cndmask_b32 v81, 0, v18, vcc
    v_cmp_eq_u32 vcc, 2, v13
    s_nop 1
    v_cndmask_b32 v82, 0, v18, vcc
    v_cmp_eq_u32 vcc, 3, v13
    s_nop 1
    v_cndmask_b32 v83, 0, v18, vcc
    v_and_b32 v38, 15, v0
    v_lshlrev_b32 v38, 8, v38
    v_lshrrev_b32 v39, 1, v2
    v_lshl_add_u32 v38, v39, 7, v38
    v_and_b32 v39, 1, v2
    v_lshl_add_u32 v38, v39, 4, v38
    s_mul_i32 s57, s60, 768
    s_lshl_b32 s59, s61, 5
    s_add_u32 s57, s57, s59
    s_add_u32 s57, s57, 123968
    v_add_u32 v38, s57, v38
    v_mul_u32_u24 v39, 640, v1
    v_lshl_add_u32 v39, v10, 4, v39
    v_mul_u32_u24 v15, 80, v2
    v_add_u32 v39, v39, v15
    s_mul_i32 s57, s53, 10240
    s_mul_i32 s59, s5, 1280
    s_add_u32 s57, s57, s59
    s_add_u32 s57, s57, 131072
    v_add_u32 v39, s57, v39
    s_mov_b32 s57, 125504
    v_lshl_add_u32 v13, v1, 2, s57
    v_and_b32 v6, 15, v0
    v_min_u32 v6, 2, v6
    v_mul_u32_u24 v6, 1344, v6
    v_lshl_add_u32 v6, v2, 4, v6
    s_add_u32 s59, s99, s60
    s_mul_i32 s57, s59, 320
    s_add_u32 s57, s57, 125568
    v_add_u32 v93, s57, v6
    s_xor_b32 s57, s59, 2
    s_mul_i32 s57, s57, 320
    s_add_u32 s57, s57, 125568
    v_add_u32 v6, s57, v6
    v_mov_b32 v85, s6
    v_mov_b32 v87, s6
    v_mov_b32 v89, s6
    v_mov_b32 v91, s6
    s_barrier
    s_cmp_ge_u32 s58, 4
    s_cbranch_scc1 L_noload
    s_mov_b32 s40, s24
    s_mov_b32 s41, s25
    s_mov_b32 s42, 0x21c000
    s_mov_b32 s43, 0x20000
    s_mov_b32 s44, s26
    s_mov_b32 s45, s27
    s_mov_b32 s46, 0x21c000
    s_mov_b32 s47, 0x20000
    s_mov_b32 s48, s28
    s_mov_b32 s49, s29
    s_mov_b32 s50, 0x21c000
    s_mov_b32 s51, 0x20000
    s_waitcnt vmcnt(5)
    s_add_u32 m0, s54, 1024
    s_nop 0
    buffer_load_dwordx4 v100, s[40:43], s55 offen lds
    s_waitcnt vmcnt(5)
    s_add_u32 m0, s54, 42000
    s_nop 0
    buffer_load_dwordx4 v100, s[44:47], s55 offen lds
    s_add_u32 s55, s55, 55296
    s_waitcnt vmcnt(5)
    s_add_u32 m0, s54, 2048
    s_nop 0
    buffer_load_dwordx4 v100, s[40:43], s55 offen lds
    s_waitcnt vmcnt(5)
    s_add_u32 m0, s54, 43024
    s_nop 0
    buffer_load_dwordx4 v100, s[44:47], s55 offen lds
    s_add_u32 s55, s55, 55296
    s_waitcnt vmcnt(5)
    s_add_u32 m0, s54, 3072
    s_nop 0
    buffer_load_dwordx4 v100, s[40:43], s55 offen lds
    s_waitcnt vmcnt(5)
    s_add_u32 m0, s54, 44048
    s_nop 0
    buffer_load_dwordx4 v100, s[44:47], s55 offen lds
    s_add_u32 s55, s55, 55296
    s_waitcnt vmcnt(5)
    s_add_u32 m0, s54, 4096
    s_nop 0
    buffer_load_dwordx4 v100, s[40:43], s55 offen lds
    s_waitcnt vmcnt(5)
    s_add_u32 m0, s54, 45072
    s_nop 0
    buffer_load_dwordx4 v100, s[44:47], s55 offen lds
    s_add_u32 s55, s55, 55296
    s_barrier
    s_barrier
    s_add_u32 s55, s55, s62
    s_add_u32 s54, s54, s96
    s_add_u32 m0, s54, 5120
    s_nop 0
    buffer_load_dwordx4 v100, s[40:43], s55 offen lds
    s_add_u32 m0, s54, 46096
    s_nop 0
    buffer_load_dwordx4 v100, s[44:47], s55 offen lds
    s_add_u32 s55, s55, 55296
    s_add_u32 m0, s54, 6144
    s_nop 0
    buffer_load_dwordx4 v100, s[40:43], s55 offen lds
    s_add_u32 m0, s54, 47120
    s_nop 0
    buffer_load_dwordx4 v100, s[44:47], s55 offen lds
    s_add_u32 s55, s55, 55296
    s_add_u32 m0, s54, 7168
    s_nop 0
    buffer_load_dwordx4 v100, s[40:43], s55 offen lds
    s_add_u32 m0, s54, 48144
    s_nop 0
    buffer_load_dwordx4 v100, s[44:47], s55 offen lds
    s_add_u32 s55, s55, 55296
    s_add_u32 m0, s54, 8192
    s_nop 0
    buffer_load_dwordx4 v100, s[40:43], s55 offen lds
    s_add_u32 m0, s54, 49168
    s_nop 0
    buffer_load_dwordx4 v100, s[44:47], s55 offen lds
    s_add_u32 s55, s55, 55296
    s_add_u32 m0, s54, 9216
    s_nop 0
    buffer_load_dwordx4 v100, s[40:43], s55 offen lds
    s_add_u32 m0, s54, 50192
    s_nop 0
    buffer_load_dwordx4 v100, s[44:47], s55 offen lds
    s_add_u32 s55, s55, 55296
    s_waitcnt vmcnt(10)
    s_barrier
    s_add_u32 m0, s98, 81984
    s_nop 0
    buffer_load_dwordx4 v101, s[48:51], s97 offen lds
    s_add_u32 m0, s98, 86080
    s_nop 0
    buffer_load_dwordx4 v102, s[48:51], s97 offen lds
    s_add_u32 m0, s98, 90176
    s_nop 0
    buffer_load_dwordx4 v103, s[48:51], s97 offen lds
    s_add_u32 m0, s98, 94272
    s_nop 0
    buffer_load_dwordx4 v104, s[48:51], s97 offen lds
    s_add_u32 m0, s98, 98368
    s_nop 0
    buffer_load_dwordx4 v105, s[48:51], s97 offen lds
    s_add_u32 m0, s98, 102464
    s_nop 0
    buffer_load_dwordx4 v106, s[48:51], s97 offen lds
    s_add_u32 m0, s98, 106560
    s_nop 0
    buffer_load_dwordx4 v107, s[48:51], s97 offen lds
    s_add_u32 m0, s98, 110656
    s_nop 0
    buffer_load_dwordx4 v108, s[48:51], s97 offen lds
    s_add_u32 m0, s98, 114752
    s_nop 0
    buffer_load_dwordx4 v109, s[48:51], s97 offen lds
    s_add_u32 m0, s98, 118848
    s_nop 0
    buffer_load_dwordx4 v110, s[48:51], s97 offen lds
    ds_read_b64_tr_b16 a[0:1], v92 offset:0
    ds_read_b64_tr_b16 a[2:3], v92 offset:256
    ds_read_b64_tr_b16 a[4:5], v92 offset:2048
    ds_read_b64_tr_b16 a[6:7], v92 offset:2304
    ds_read_b64_tr_b16 a[8:9], v92 offset:4096
    ds_read_b64_tr_b16 a[10:11], v92 offset:4352
    ds_read_b64_tr_b16 a[12:13], v92 offset:6144
    ds_read_b64_tr_b16 a[14:15], v92 offset:6400
    ds_read_b64_tr_b16 a[16:17], v92 offset:8192
    ds_read_b64_tr_b16 a[18:19], v92 offset:8448
    s_waitcnt vmcnt(10)
    s_branch L_nopoll
L_noload:
    s_barrier
    s_cmp_eq_u32 s5, 0
    s_cbranch_scc1 L_poller
    s_barrier
    s_barrier
    ds_read_b64_tr_b16 a[0:1], v92 offset:0
    ds_read_b64_tr_b16 a[2:3], v92 offset:256
    ds_read_b64_tr_b16 a[4:5], v92 offset:2048
    ds_read_b64_tr_b16 a[6:7], v92 offset:2304
    ds_read_b64_tr_b16 a[8:9], v92 offset:4096
    ds_read_b64_tr_b16 a[10:11], v92 offset:4352
    ds_read_b64_tr_b16 a[12:13], v92 offset:6144
    ds_read_b64_tr_b16 a[14:15], v92 offset:6400
    ds_read_b64_tr_b16 a[16:17], v92 offset:8192
    ds_read_b64_tr_b16 a[18:19], v92 offset:8448
    s_cmp_lg_u32 s5, 5
    s_cbranch_scc1 L_nopoll
    s_mov_b32 s48, s28
    s_mov_b32 s49, s29
    s_mov_b32 s50, 0x21c000
    s_mov_b32 s51, 0x20000
    s_mov_b32 m0, 122944
    s_nop 0
    buffer_load_dwordx4 v111, s[48:51], s97 offen lds
    s_lshl_b32 s59, s2, 7
    s_add_u32 s59, s59, 65536
    v_mov_b32 v32, s6
    v_mov_b32 v33, s7
    v_mov_b32 v34, s59
    s_mov_b64 exec, 0x1
    buffer_store_dwordx2 v[32:33], v34, s[36:39], 0 offen sc1
    s_mov_b64 exec, -1
    s_branch L_nopoll
L_poller:
    v_lshlrev_b32 v32, 4, v0
    s_mov_b32 s58, 36864
    buffer_load_dwordx4 v[16:19], v32, s[36:39], s58 offen offset:0 sc1
    buffer_load_dwordx4 v[20:23], v32, s[36:39], s58 offen offset:1024 sc1
    buffer_load_dwordx4 v[24:27], v32, s[36:39], s58 offen offset:2048 sc1
    buffer_load_dwordx4 v[28:31], v32, s[36:39], s58 offen offset:3072 sc1
    s_barrier
    s_mov_b32 s40, s8
    s_mov_b32 s41, s9
    s_mov_b32 s42, 0x280000
    s_mov_b32 s43, 0x20000
    s_waitcnt vmcnt(0)
    s_mov_b32 s59, 0
L_cm:
    v_xor_b32 v17, s6, v17
    v_xor_b32 v19, s6, v19
    v_xor_b32 v21, s6, v21
    v_xor_b32 v23, s6, v23
    v_xor_b32 v25, s6, v25
    v_xor_b32 v27, s6, v27
    v_xor_b32 v29, s6, v29
    v_xor_b32 v31, s6, v31
    v_or3_b32 v17, v17, v19, v21
    v_or3_b32 v23, v23, v25, v27
    v_or_b32 v29, v29, v31
    v_or3_b32 v17, v17, v23, v29
    v_cmp_ne_u32 vcc, 0, v17
    s_nop 0
    s_cbranch_vccz L_cm_ok
    buffer_load_dwordx4 v[16:19], v32, s[36:39], s58 offen offset:0 sc1
    buffer_load_dwordx4 v[20:23], v32, s[36:39], s58 offen offset:1024 sc1
    buffer_load_dwordx4 v[24:27], v32, s[36:39], s58 offen offset:2048 sc1
    buffer_load_dwordx4 v[28:31], v32, s[36:39], s58 offen offset:3072 sc1
    s_add_u32 s59, s59, 1
    s_cmp_lt_u32 s59, 65536
    s_waitcnt vmcnt(0)
    s_cbranch_scc1 L_cm
L_cm_ok:
    v_min_u32 v17, v16, v20
    v_max_u32 v16, v16, v20
    v_max3_u32 v18, v18, v22, v17
    v_min_u32 v19, v24, v28
    v_max_u32 v24, v24, v28
    v_max3_u32 v26, v26, v30, v19
    v_min_u32 v17, v16, v24
    v_max_u32 v16, v16, v24
    v_max3_u32 v18, v18, v26, v17
    s_nop 0
    v_min_u32_dpp v17, v16, v16 row_ror:1 row_mask:0xf bank_mask:0xf
    v_max_u32_dpp v19, v18, v18 row_ror:1 row_mask:0xf bank_mask:0xf
    v_max_u32_dpp v16, v16, v16 row_ror:1 row_mask:0xf bank_mask:0xf
    v_max_u32 v18, v17, v19
    s_nop 0
    v_min_u32_dpp v17, v16, v16 row_ror:2 row_mask:0xf bank_mask:0xf
    v_max_u32_dpp v19, v18, v18 row_ror:2 row_mask:0xf bank_mask:0xf
    v_max_u32_dpp v16, v16, v16 row_ror:2 row_mask:0xf bank_mask:0xf
    v_max_u32 v18, v17, v19
    s_nop 0
    v_min_u32_dpp v17, v16, v16 row_ror:4 row_mask:0xf bank_mask:0xf
    v_max_u32_dpp v19, v18, v18 row_ror:4 row_mask:0xf bank_mask:0xf
    v_max_u32_dpp v16, v16, v16 row_ror:4 row_mask:0xf bank_mask:0xf
    v_max_u32 v18, v17, v19
    s_nop 0
    v_min_u32_dpp v17, v16, v16 row_ror:8 row_mask:0xf bank_mask:0xf
    v_max_u32_dpp v19, v18, v18 row_ror:8 row_mask:0xf bank_mask:0xf
    v_max_u32_dpp v16, v16, v16 row_ror:8 row_mask:0xf bank_mask:0xf
    v_max_u32 v18, v17, v19
    v_readlane_b32 s54, v16, 0
    v_readlane_b32 s55, v18, 0
    v_readlane_b32 s56, v16, 16
    v_readlane_b32 s59, v18, 16
    s_nop 0
    s_max_u32 s55, s55, s59
    s_min_u32 s59, s54, s56
    s_max_u32 s54, s54, s56
    s_max_u32 s55, s55, s59
    v_readlane_b32 s56, v16, 32
    v_readlane_b32 s59, v18, 32
    s_nop 0
    s_max_u32 s55, s55, s59
    s_min_u32 s59, s54, s56
    s_max_u32 s54, s54, s56
    s_max_u32 s55, s55, s59
    v_readlane_b32 s56, v16, 48
    v_readlane_b32 s59, v18, 48
    s_nop 0
    s_max_u32 s55, s55, s59
    s_min_u32 s59, s54, s56
    s_max_u32 s54, s54, s56
    s_max_u32 s55, s55, s59
    s_andn2_b32 s56, 0x7ff, s54
    s_andn2_b32 s57, 0x7ff, s55
    s_mul_i32 s56, s56, 1280
    s_mul_i32 s57, s57, 1280
    s_mov_b32 m0, 125568
    s_nop 0
    buffer_load_dwordx4 v32, s[40:43], s56 offen lds
    s_mov_b64 exec, 0xffff
    buffer_load_dwordx4 v32, s[40:43], s56 offen offset:1024 lds
    s_mov_b64 exec, -1
    s_mov_b32 m0, 126912
    s_nop 0
    buffer_load_dwordx4 v32, s[40:43], s57 offen lds
    s_mov_b64 exec, 0xffff
    buffer_load_dwordx4 v32, s[40:43], s57 offen offset:1024 lds
    s_mov_b64 exec, -1
    v_mov_b32 v16, s54
    v_mov_b32 v17, s55
    v_cmp_eq_u32 vcc, 1, v1
    s_nop 1
    v_cndmask_b32 v5, v16, v17, vcc
    v_not_b32 v3, v5
    v_and_b32 v7, 0x7ff, v3
    v_lshlrev_b32 v7, 3, v7
    s_mov_b32 s57, 98304
    buffer_load_dwordx2 v[8:9], v7, s[36:39], s57 offen sc1
    s_andn2_b32 s56, 0x7ff, s54
    s_andn2_b32 s58, 0x7ff, s55
    s_cmp_lg_u32 s4, 20
    s_cbranch_scc1 L_ntp
    s_lshl_b32 s59, s58, 16
    s_or_b32 s59, s59, s56
    v_mov_b32 v16, s59
    s_lshl_b32 s59, s3, 7
    s_add_u32 s59, s59, 40960
    v_mov_b32 v17, s6
    v_mov_b32 v3, s59
    s_mov_b64 exec, 0x1
    buffer_store_dwordx2 v[16:17], v3, s[36:39], 0 offen sc1
    s_mov_b64 exec, -1
L_ntp:
    s_barrier
    ds_read_b64_tr_b16 a[0:1], v92 offset:0
    ds_read_b64_tr_b16 a[2:3], v92 offset:256
    ds_read_b64_tr_b16 a[4:5], v92 offset:2048
    ds_read_b64_tr_b16 a[6:7], v92 offset:2304
    ds_read_b64_tr_b16 a[8:9], v92 offset:4096
    ds_read_b64_tr_b16 a[10:11], v92 offset:4352
    ds_read_b64_tr_b16 a[12:13], v92 offset:6144
    ds_read_b64_tr_b16 a[14:15], v92 offset:6400
    ds_read_b64_tr_b16 a[16:17], v92 offset:8192
    ds_read_b64_tr_b16 a[18:19], v92 offset:8448
    v_and_b32 v5, s52, v5
    v_ashrrev_i32 v10, 31, v5
    v_not_b32 v10, v10
    v_or_b32 v10, 0x80000000, v10
    v_xor_b32 v5, v5, v10
    v_and_b32 v5, s52, v5
    v_mul_f32 v5, 0xbfb8aa3b, v5
    v_exp_f32 v5, v5
    s_nop 0
    v_add_f32 v5, 1.0, v5
    v_rcp_f32 v5, v5
    s_cmp_eq_u32 s4, 20
    s_cbranch_scc1 L_w1
    s_waitcnt vmcnt(0)
L_w1:
    s_waitcnt vmcnt(1)
    s_mov_b32 s59, 0
L_ms:
    v_xor_b32 v9, s6, v9
    v_cmp_ne_u32 vcc, 0, v9
    s_nop 0
    s_cbranch_vccz L_ms_ok
    buffer_load_dwordx2 v[8:9], v7, s[36:39], s57 offen sc1
    s_add_u32 s59, s59, 1
    s_cmp_lt_u32 s59, 65536
    s_waitcnt vmcnt(0)
    s_cbranch_scc1 L_ms
L_ms_ok:
    ds_write2_b32 v13, v5, v8 offset0:0 offset1:2
L_nopoll:
    s_mov_b32 s42, 0x2020202
    s_mov_b32 s43, 0x2020202
    s_mov_b32 s44, 0x4040404
    s_mov_b32 s45, 0x4040404
    s_mov_b32 s46, 0x8080808
    s_mov_b32 s47, 0x8080808
    s_mov_b32 s48, 0x10101010
    s_mov_b32 s49, 0x10101010
    s_waitcnt lgkmcnt(0)
    s_barrier
    ds_read_b128 v[40:43], v93 offset:0
    ds_read_b128 v[44:47], v93 offset:64
    ds_read_b128 v[48:51], v93 offset:128
    ds_read_b128 v[52:55], v93 offset:192
    ds_read_b128 v[56:59], v93 offset:256
    ds_read_b64_tr_b16 a[20:21], v14 offset:0
    ds_read_b64_tr_b16 a[22:23], v14 offset:256
    ds_read_b128 v[60:63], v6 offset:0
    ds_read_b64_tr_b16 a[24:25], v14 offset:2048
    ds_read_b64_tr_b16 a[26:27], v14 offset:2304
    ds_read_b128 v[64:67], v6 offset:64
    ds_read_b64_tr_b16 a[28:29], v14 offset:4096
    ds_read_b64_tr_b16 a[30:31], v14 offset:4352
    ds_read_b128 v[68:71], v6 offset:128
    s_waitcnt lgkmcnt(9)
    v_mfma_f32_16x16x32_bf16 v[28:31], a[0:3], v[40:43], 0
    ds_read_b64_tr_b16 a[32:33], v14 offset:6144
    ds_read_b64_tr_b16 a[34:35], v14 offset:6400
    ds_read_b128 v[72:75], v6 offset:192
    v_mfma_f32_16x16x32_bf16 v[28:31], a[4:7], v[44:47], v[28:31]
    ds_read_b64_tr_b16 a[36:37], v14 offset:8192
    ds_read_b64_tr_b16 a[38:39], v14 offset:8448
    ds_read_b128 v[76:79], v6 offset:256
    v_mfma_f32_16x16x32_bf16 v[28:31], a[8:11], v[48:51], v[28:31]
    v_mfma_f32_16x16x32_bf16 v[28:31], a[12:15], v[52:55], v[28:31]
    v_mfma_f32_16x16x32_bf16 v[28:31], a[16:19], v[56:59], v[28:31]
    s_waitcnt lgkmcnt(12)
    v_mfma_f32_16x16x32_bf16 v[28:31], a[20:23], v[60:63], v[28:31]
    ds_read2_b32 v[4:5], v13 offset0:2 offset1:0
    s_waitcnt lgkmcnt(10)
    v_mfma_f32_16x16x32_bf16 v[28:31], a[24:27], v[64:67], v[28:31]
    s_waitcnt lgkmcnt(7)
    v_mfma_f32_16x16x32_bf16 v[28:31], a[28:31], v[68:71], v[28:31]
    s_waitcnt lgkmcnt(4)
    v_mfma_f32_16x16x32_bf16 v[28:31], a[32:35], v[72:75], v[28:31]
    s_waitcnt lgkmcnt(1)
    v_mfma_f32_16x16x32_bf16 v[28:31], a[36:39], v[76:79], v[28:31]
    s_waitcnt lgkmcnt(0)
    v_and_b32 v9, s52, v4
    v_lshlrev_b32 v8, 16, v4
    v_rcp_f32 v9, v9
    s_nop 0
    v_mul_f32 v5, v5, v9
    s_mov_b32 exec_lo, 0x70007
    s_mov_b32 exec_hi, 0x70007
    ds_write_b128 v38, v[28:31]
    s_mov_b64 exec, -1
    s_waitcnt lgkmcnt(0)
    s_barrier
    ds_read2_b32 v[28:29], v36 offset0:0 offset1:32
    ds_read2_b32 v[30:31], v36 offset0:192 offset1:224
    ds_read2_b32 v[32:33], v37 offset0:0 offset1:32
    ds_read2_b32 v[34:35], v37 offset0:192 offset1:224
    s_waitcnt lgkmcnt(2)
    v_add_f32 v28, v28, v30
    v_add_f32 v29, v29, v31
    s_waitcnt lgkmcnt(0)
    v_add_f32 v32, v32, v34
    v_add_f32 v33, v33, v35
    v_fma_f32 v28, -v8, v32, v28
    v_fma_f32 v29, -v8, v33, v29
    v_mul_f32 v28, v28, v9
    v_mul_f32 v29, v29, v5
    v_mul_f32 v30, 0xbfb8aa3b, v28
    v_exp_f32 v30, v30
    v_mul_f32 v29, v29, v28
    v_add_f32 v30, 1.0, v30
    v_rcp_f32 v30, v30
    s_nop 0
    v_mul_f32 v29, v29, v30
    v_cvt_pk_bf16_f32 v29, v29, v29
    v_and_b32 v32, v29, v80
    v_and_b32 v33, v29, v81
    v_and_b32 v34, v29, v82
    v_and_b32 v35, v29, v83
    v_or_b32_dpp v32, v32, v32 quad_perm:[1,0,3,2] row_mask:0xf bank_mask:0xf
    v_or_b32_dpp v33, v33, v33 quad_perm:[1,0,3,2] row_mask:0xf bank_mask:0xf
    v_or_b32_dpp v34, v34, v34 quad_perm:[1,0,3,2] row_mask:0xf bank_mask:0xf
    v_or_b32_dpp v35, v35, v35 quad_perm:[1,0,3,2] row_mask:0xf bank_mask:0xf
    v_or_b32_dpp v32, v32, v32 quad_perm:[2,3,0,1] row_mask:0xf bank_mask:0xf
    v_or_b32_dpp v33, v33, v33 quad_perm:[2,3,0,1] row_mask:0xf bank_mask:0xf
    v_or_b32_dpp v34, v34, v34 quad_perm:[2,3,0,1] row_mask:0xf bank_mask:0xf
    v_or_b32_dpp v35, v35, v35 quad_perm:[2,3,0,1] row_mask:0xf bank_mask:0xf
    v_or_b32_dpp v32, v32, v32 row_half_mirror row_mask:0xf bank_mask:0xf
    v_or_b32_dpp v33, v33, v33 row_half_mirror row_mask:0xf bank_mask:0xf
    v_or_b32_dpp v34, v34, v34 row_half_mirror row_mask:0xf bank_mask:0xf
    v_or_b32_dpp v35, v35, v35 row_half_mirror row_mask:0xf bank_mask:0xf
    s_waitcnt vmcnt(0)
    s_barrier
    ds_read_b64_tr_b16 a[40:41], v12 offset:0
    ds_read_b64_tr_b16 a[42:43], v12 offset:5248
    ds_read_b64_tr_b16 a[44:45], v12 offset:32
    ds_read_b64_tr_b16 a[46:47], v12 offset:5280
    ds_read_b64_tr_b16 a[48:49], v12 offset:64
    ds_read_b64_tr_b16 a[50:51], v12 offset:5312
    ds_read_b64_tr_b16 a[52:53], v12 offset:96
    ds_read_b64_tr_b16 a[54:55], v12 offset:5344
    ds_read_b64_tr_b16 a[56:57], v12 offset:128
    ds_read_b64_tr_b16 a[58:59], v12 offset:5376
    s_waitcnt lgkmcnt(8)
    v_mfma_f32_16x16x32_bf16 v[40:43], a[40:43], v[32:35], 0
    s_waitcnt lgkmcnt(6)
    v_mfma_f32_16x16x32_bf16 v[44:47], a[44:47], v[32:35], 0
    s_waitcnt lgkmcnt(4)
    v_mfma_f32_16x16x32_bf16 v[48:51], a[48:51], v[32:35], 0
    s_waitcnt lgkmcnt(2)
    v_mfma_f32_16x16x32_bf16 v[52:55], a[52:55], v[32:35], 0
    s_waitcnt lgkmcnt(0)
    v_mfma_f32_16x16x32_bf16 v[56:59], a[56:59], v[32:35], 0
    s_nop 1
    v_cndmask_b32 v40, v40, v44, s[42:43]
    v_cndmask_b32 v41, v41, v45, s[42:43]
    v_cndmask_b32 v42, v42, v46, s[42:43]
    v_cndmask_b32 v43, v43, v47, s[42:43]
    v_cndmask_b32 v40, v40, v48, s[44:45]
    v_cndmask_b32 v41, v41, v49, s[44:45]
    v_cndmask_b32 v42, v42, v50, s[44:45]
    v_cndmask_b32 v43, v43, v51, s[44:45]
    v_cndmask_b32 v40, v40, v52, s[46:47]
    v_cndmask_b32 v41, v41, v53, s[46:47]
    v_cndmask_b32 v42, v42, v54, s[46:47]
    v_cndmask_b32 v43, v43, v55, s[46:47]
    v_cndmask_b32 v84, v40, v56, s[48:49]
    v_cndmask_b32 v86, v41, v57, s[48:49]
    v_cndmask_b32 v88, v42, v58, s[48:49]
    v_cndmask_b32 v90, v43, v59, s[48:49]
    s_mov_b32 exec_lo, 0x1f1f1f1f
    s_mov_b32 exec_hi, 0x1f1f1f1f
    buffer_store_dwordx4 v[84:87], v39, s[36:39], 0 offen sc1
    buffer_store_dwordx4 v[88:91], v39, s[36:39], 0 offen offset:320 sc1
    s_mov_b64 exec, -1
L_fin:
L_end:
    s_endpgm
L_sslow:
    buffer_store_dwordx4 v[12:15], v44, s[36:39], s56 offen offset:2048 sc1
    buffer_store_dwordx4 v[12:15], v44, s[36:39], s56 offen offset:3072 sc1
    buffer_load_dwordx2 v[42:43], v3, s[36:39], s61 offen sc1
    s_waitcnt vmcnt(0)
    s_mov_b64 exec, 0x1
    buffer_store_dword v31, v30, s[36:39], s61 offen offset:1024 sc1
    s_branch L_sback
L_msk0:
    s_and_b32 s56, s62, 7
    s_and_b32 s57, s63, 7
    s_cmp_eq_u32 s56, 0
    s_cselect_b64 s[54:55], s[44:45], 0
    s_cmp_eq_u32 s57, 0
    s_cselect_b64 vcc, s[46:47], 0
    s_nor_b64 exec, s[54:55], vcc
    s_cbranch_execz L_ms0_0
    buffer_store_dword v48, v5, s[40:43], 0 offen offset:0
L_ms0_0:
    s_cmp_eq_u32 s56, 1
    s_cselect_b64 s[54:55], s[44:45], 0
    s_cmp_eq_u32 s57, 1
    s_cselect_b64 vcc, s[46:47], 0
    s_nor_b64 exec, s[54:55], vcc
    s_cbranch_execz L_ms0_1
    buffer_store_dword v49, v5, s[40:43], 0 offen offset:1280
L_ms0_1:
    s_cmp_eq_u32 s56, 2
    s_cselect_b64 s[54:55], s[44:45], 0
    s_cmp_eq_u32 s57, 2
    s_cselect_b64 vcc, s[46:47], 0
    s_nor_b64 exec, s[54:55], vcc
    s_cbranch_execz L_ms0_2
    buffer_store_dword v50, v5, s[40:43], 0 offen offset:2560
L_ms0_2:
    s_cmp_eq_u32 s56, 3
    s_cselect_b64 s[54:55], s[44:45], 0
    s_cmp_eq_u32 s57, 3
    s_cselect_b64 vcc, s[46:47], 0
    s_nor_b64 exec, s[54:55], vcc
    s_cbranch_execz L_ms0_3
    buffer_store_dword v51, v5, s[40:43], 0 offen offset:3840
L_ms0_3:
    s_cmp_eq_u32 s56, 4
    s_cselect_b64 s[54:55], s[44:45], 0
    s_cmp_eq_u32 s57, 4
    s_cselect_b64 vcc, s[46:47], 0
    s_nor_b64 exec, s[54:55], vcc
    s_cbranch_execz L_ms0_4
    buffer_store_dword v52, v5, s[40:43], s49 offen offset:0
L_ms0_4:
    s_cmp_eq_u32 s56, 5
    s_cselect_b64 s[54:55], s[44:45], 0
    s_cmp_eq_u32 s57, 5
    s_cselect_b64 vcc, s[46:47], 0
    s_nor_b64 exec, s[54:55], vcc
    s_cbranch_execz L_ms0_5
    buffer_store_dword v53, v5, s[40:43], s49 offen offset:1280
L_ms0_5:
    s_cmp_eq_u32 s56, 6
    s_cselect_b64 s[54:55], s[44:45], 0
    s_cmp_eq_u32 s57, 6
    s_cselect_b64 vcc, s[46:47], 0
    s_nor_b64 exec, s[54:55], vcc
    s_cbranch_execz L_ms0_6
    buffer_store_dword v54, v5, s[40:43], s49 offen offset:2560
L_ms0_6:
    s_cmp_eq_u32 s56, 7
    s_cselect_b64 s[54:55], s[44:45], 0
    s_cmp_eq_u32 s57, 7
    s_cselect_b64 vcc, s[46:47], 0
    s_nor_b64 exec, s[54:55], vcc
    s_cbranch_execz L_ms0_7
    buffer_store_dword v55, v5, s[40:43], s49 offen offset:3840
L_ms0_7:
    s_mov_b64 exec, -1
    s_branch L_mskd0
L_msk1:
    s_and_b32 s56, s62, 7
    s_and_b32 s57, s63, 7
    s_cmp_eq_u32 s56, 0
    s_cselect_b64 s[54:55], s[44:45], 0
    s_cmp_eq_u32 s57, 0
    s_cselect_b64 vcc, s[46:47], 0
    s_nor_b64 exec, s[54:55], vcc
    s_cbranch_execz L_ms1_0
    buffer_store_dword v48, v6, s[40:43], 0 offen offset:0
L_ms1_0:
    s_cmp_eq_u32 s56, 1
    s_cselect_b64 s[54:55], s[44:45], 0
    s_cmp_eq_u32 s57, 1
    s_cselect_b64 vcc, s[46:47], 0
    s_nor_b64 exec, s[54:55], vcc
    s_cbranch_execz L_ms1_1
    buffer_store_dword v49, v6, s[40:43], 0 offen offset:1280
L_ms1_1:
    s_cmp_eq_u32 s56, 2
    s_cselect_b64 s[54:55], s[44:45], 0
    s_cmp_eq_u32 s57, 2
    s_cselect_b64 vcc, s[46:47], 0
    s_nor_b64 exec, s[54:55], vcc
    s_cbranch_execz L_ms1_2
    buffer_store_dword v50, v6, s[40:43], 0 offen offset:2560
L_ms1_2:
    s_cmp_eq_u32 s56, 3
    s_cselect_b64 s[54:55], s[44:45], 0
    s_cmp_eq_u32 s57, 3
    s_cselect_b64 vcc, s[46:47], 0
    s_nor_b64 exec, s[54:55], vcc
    s_cbranch_execz L_ms1_3
    buffer_store_dword v51, v6, s[40:43], 0 offen offset:3840
L_ms1_3:
    s_cmp_eq_u32 s56, 4
    s_cselect_b64 s[54:55], s[44:45], 0
    s_cmp_eq_u32 s57, 4
    s_cselect_b64 vcc, s[46:47], 0
    s_nor_b64 exec, s[54:55], vcc
    s_cbranch_execz L_ms1_4
    buffer_store_dword v52, v6, s[40:43], s49 offen offset:0
L_ms1_4:
    s_cmp_eq_u32 s56, 5
    s_cselect_b64 s[54:55], s[44:45], 0
    s_cmp_eq_u32 s57, 5
    s_cselect_b64 vcc, s[46:47], 0
    s_nor_b64 exec, s[54:55], vcc
    s_cbranch_execz L_ms1_5
    buffer_store_dword v53, v6, s[40:43], s49 offen offset:1280
L_ms1_5:
    s_cmp_eq_u32 s56, 6
    s_cselect_b64 s[54:55], s[44:45], 0
    s_cmp_eq_u32 s57, 6
    s_cselect_b64 vcc, s[46:47], 0
    s_nor_b64 exec, s[54:55], vcc
    s_cbranch_execz L_ms1_6
    buffer_store_dword v54, v6, s[40:43], s49 offen offset:2560
L_ms1_6:
    s_cmp_eq_u32 s56, 7
    s_cselect_b64 s[54:55], s[44:45], 0
    s_cmp_eq_u32 s57, 7
    s_cselect_b64 vcc, s[46:47], 0
    s_nor_b64 exec, s[54:55], vcc
    s_cbranch_execz L_ms1_7
    buffer_store_dword v55, v6, s[40:43], s49 offen offset:3840
L_ms1_7:
    s_mov_b64 exec, -1
    s_branch L_mskd1
L_codeend:
.section .rodata,"a"
.p2align 6
.amdhsa_kernel parallel_sum__ssm_conv_h3__moe_arch_mod__prompt_kernel
  .amdhsa_next_free_vgpr 256
  .amdhsa_next_free_sgpr 102
  .amdhsa_accum_offset 128
  .amdhsa_group_segment_fixed_size 0
  .amdhsa_kernarg_size 112
  .amdhsa_user_sgpr_count 2
  .amdhsa_user_sgpr_kernarg_segment_ptr 1
  .amdhsa_system_sgpr_workgroup_id_x 1
  .amdhsa_float_denorm_mode_32 3
.end_amdhsa_kernel
```
